```python
import torch

def _softmax(x, axis=-1):
    return torch.softmax(x, dim=axis)
def _gelu(x):
    return torch.nn.functional.gelu(x, approximate="tanh")
def _silu(x):
    return torch.nn.functional.silu(x)
def _sigmoid(x):
    return torch.sigmoid(x)
def _layernorm(x, axis=-1, eps=1e-5):
    m = x.mean(dim=axis, keepdim=True)
    v = x.var(dim=axis, keepdim=True, unbiased=False)
    return (x - m) / torch.sqrt(v + eps)
def _scatter_add(tgt, idx, src, axis=0):
    return tgt.clone().index_add_(axis, idx, src)
def _segment_sum(src, seg, n):
    out = torch.zeros((n,) + src.shape[1:], dtype=src.dtype)
    return out.index_add_(0, seg, src)
def _pad(x, pw):
    flat = tuple(v for pair in reversed(pw) for v in pair)
    return torch.nn.functional.pad(x, flat)

kernel_name = 'parallel_sum__ssm_conv_s4__glu_gated_bilinear__prompt'

def setup_inputs():

    _w = (lambda a: (lambda t: t.to(torch.bfloat16) if t.is_floating_point() else t)(torch.as_tensor(a)))
    def _A_setup():
        B, L, D, N = 1, 2048, 512, 128
        A_re = -(lambda _x: torch.exp(torch.as_tensor(_x)))((lambda *s: torch.randn(*s, dtype=torch.bfloat16) * 6.4)(D, N))
        A_im = torch.pi * (lambda *s: torch.randn(*s, dtype=torch.bfloat16) * 0.05)(D, N)
        B_re = (lambda *s: torch.randn(*s, dtype=torch.bfloat16) * 0.1)(D, N)
        B_im = (lambda *s: torch.randn(*s, dtype=torch.bfloat16) * 0.1)(D, N)
        C_re = (lambda *s: torch.randn(*s, dtype=torch.bfloat16) * 0.1)(D, N)
        C_im = (lambda *s: torch.randn(*s, dtype=torch.bfloat16) * 0.1)(D, N)
        log_dt = (lambda *s: torch.randn(*s, dtype=torch.bfloat16) * 0.05)(D) * 0.5 - 4.0
        Dskip = (lambda *s: torch.randn(*s, dtype=torch.bfloat16) * 0.05)(D)
        return {
            "u": _w((lambda *s: torch.randn(*s, dtype=torch.bfloat16) * 0.05)(B, L, D)),
            "A_re": _w(A_re),
            "A_im": _w(A_im),
            "B_re": _w(B_re),
            "B_im": _w(B_im),
            "C_re": _w(C_re),
            "C_im": _w(C_im),
            "log_dt": _w(log_dt),
            "Dskip": _w(Dskip),
        }
    _A_in = _A_setup()

    def _B_setup():
        B, S, D, F = 1, 2048, 512, 1376
        return {
            "x": _w((lambda *s: torch.randn(*s, dtype=torch.bfloat16) * 0.05)(B, S, D)),
            "w_gate": _w((lambda *s: torch.randn(*s, dtype=torch.bfloat16) * 0.4)(D, F) * (D ** -0.5)),
            "w_up": _w((lambda *s: torch.randn(*s, dtype=torch.bfloat16) * 0.4)(D, F) * (D ** -0.5)),
            "w_down": _w((lambda *s: torch.randn(*s, dtype=torch.bfloat16) * 0.4)(F, D) * (F ** -0.5)),
        }
    _B_in = _B_setup()

    return {
        "A_u": _A_in["u"],
        "A_A_re": _A_in["A_re"],
        "A_A_im": _A_in["A_im"],
        "A_B_re": _A_in["B_re"],
        "A_B_im": _A_in["B_im"],
        "A_C_re": _A_in["C_re"],
        "A_C_im": _A_in["C_im"],
        "A_log_dt": _A_in["log_dt"],
        "A_Dskip": _A_in["Dskip"],
        "B_x": _B_in["x"],
        "B_w_gate": _B_in["w_gate"],
        "B_w_up": _B_in["w_up"],
        "B_w_down": _B_in["w_down"],
    }

def reference(A_u, A_A_re, A_A_im, A_B_re, A_B_im, A_C_re, A_C_im, A_log_dt, A_Dskip, B_x, B_w_gate, B_w_up, B_w_down):
    def _A_ref(u, A_re, A_im, B_re, B_im, C_re, C_im, log_dt, Dskip):
        Bsz, L, D = u.shape
        dt = torch.exp(log_dt)[:, None]
        A = A_re + 1j * A_im
        Bc = B_re + 1j * B_im
        Cc = C_re + 1j * C_im
        logdA = dt * A
        dB = dt * Bc
        l = (lambda x, dt: x.to(dt))(torch.arange(L), A_re.dtype)
        P = torch.exp(logdA[:, :, None] * l[None, None, :])
        K = torch.einsum("dn,dnl,dn->dl", Cc, P, dB).real
        L2 = 2 * L
        Kp = _pad(K, ((0, 0), (0, L)))
        up = (lambda x, *d: x.permute(*d))(u, 0, 2, 1)
        up = _pad(up, ((0, 0), (0, 0), (0, L)))
        Kf = (lambda x, axes=(-2,-1): torch.fft.rfft2(x.float(), dim=axes))(Kp[:, None, :], axes=(-2, -1))
        Uf = (lambda x, axes=(-2,-1): torch.fft.rfft2(x.float(), dim=axes))(up[:, :, None, :], axes=(-2, -1))
        Yf = Uf * Kf[None, :, :, :]
        y = (lambda x, s, axes=(-2,-1): torch.fft.irfft2(x, s=s, dim=axes).to(torch.bfloat16))(Yf, (1, L2), axes=(-2, -1))[:, :, 0, :L]
        y = (lambda x, *d: x.permute(*d))(y, 0, 2, 1) + u * Dskip[None, None, :]
        return y

    def _B_ref(x, w_gate, w_up, w_down):
        g = torch.einsum("bsd,df->bsf", x, w_gate)
        u = torch.einsum("bsd,df->bsf", x, w_up)
        h = g * u
        return torch.einsum("bsf,fd->bsd", h, w_down)

    x = A_u
    xn = _layernorm(x, axis=-1)
    return x + _A_ref(xn, A_A_re, A_A_im, A_B_re, A_B_im, A_C_re, A_C_im, A_log_dt, A_Dskip) + _B_ref(xn, B_w_gate, B_w_up, B_w_down)
```

```asm
; @launch grid=(256,1,1) block=(512,1,1) lds=163840
.amdgcn_target "amdgcn-amd-amdhsa--gfx950"
.text
.globl parallel_sum__ssm_conv_s4__glu_gated_bilinear__prompt_kernel
.p2align 8
.type parallel_sum__ssm_conv_s4__glu_gated_bilinear__prompt_kernel,@function
parallel_sum__ssm_conv_s4__glu_gated_bilinear__prompt_kernel:
    s_cmp_ge_u32 s2, 256
    s_cbranch_scc1 L_END
    s_load_dwordx16 s[4:19], s[0:1], 0
    s_load_dwordx16 s[20:35], s[0:1], 64
    v_lshrrev_b32 v1, 6, v0
    v_lshlrev_b32 v2, 4, v0
    v_readfirstlane_b32 s3, v1
    v_cmp_gt_u32 vcc, 346, v0
    v_add_u32 v2, 157760, v2
    v_and_b32 v0, 63, v0
    v_mov_b64 v[4:5], 0
    v_mov_b64 v[6:7], 0
    s_mov_b64 exec, vcc
    ds_write_b128 v2, v[4:7]
    s_mov_b64 exec, -1
    s_and_b32 s66, s2, 7
    s_lshr_b32 s67, s2, 3
    s_and_b32 s68, s66, 3
    s_lshr_b32 s69, s66, 2
    s_and_b32 s70, s67, 3
    s_lshl_b32 s71, s68, 2
    s_add_u32 s62, s71, s70
    s_lshl_b32 s65, s68, 3
    s_lshl_b32 s72, s69, 2
    s_add_u32 s65, s65, s72
    s_add_u32 s65, s65, s70
    s_lshr_b32 s100, s67, 2
    s_mul_i32 s63, s69, 7
    s_add_u32 s63, s63, s100
    s_and_b32 s70, s67, 1
    s_add_u32 s71, s71, s70
    s_lshl_b32 s69, s69, 1
    s_add_u32 s71, s71, s69
    s_bfe_u32 s70, s67, 0x10001
    s_add_u32 s70, s70, 14
    s_cmp_lt_u32 s67, 28
    s_cselect_b32 s62, s62, s71
    s_cselect_b32 s63, s63, s70
    s_lshl_b32 s64, s62, 4
    s_add_u32 s64, s64, s63
    s_cmp_ge_u32 s3, 4
    s_cbranch_scc1 L_S
    v_lshrrev_b32 v6, 4, v0
    v_and_b32 v7, 15, v0
    v_lshlrev_b32 v1, 4, v7
    v_lshl_add_u32 v1, v6, 11, v1
    s_lshl_b32 s66, s64, 13
    s_lshl_b32 s67, s3, 8
    s_add_u32 s66, s66, s67
    v_add_u32 v64, s66, v1
    v_lshlrev_b32 v27, 4, v0
    s_and_b32 s74, s3, 1
    s_lshr_b32 s75, s3, 1
    v_and_b32 v1, 31, v0
    v_lshrrev_b32 v2, 5, v0
    v_bfe_u32 v3, v0, 1, 3
    v_xor_b32 v3, v3, v2
    s_lshl_b32 s66, s74, 13
    s_add_u32 s66, s66, 34816
    v_lshl_add_u32 v4, v1, 7, s66
    v_xor_b32 v5, 0, v3
    v_lshl_add_u32 v16, v5, 4, v4
    v_xor_b32 v5, 2, v3
    v_lshl_add_u32 v17, v5, 4, v4
    v_xor_b32 v5, 4, v3
    v_lshl_add_u32 v18, v5, 4, v4
    v_xor_b32 v5, 6, v3
    v_lshl_add_u32 v19, v5, 4, v4
    v_bfe_u32 v3, v0, 2, 2
    v_lshl_add_u32 v3, v2, 3, v3
    v_mul_u32_u24 v3, 192, v3
    v_and_b32 v4, 3, v0
    v_lshl_add_u32 v3, v4, 3, v3
    s_mul_i32 s66, s75, 96
    v_add_u32 v3, s66, v3
    v_bfe_u32 v4, v0, 4, 1
    v_lshl_add_u32 v5, v4, 5, v3
    v_add_u32 v20, 83968, v5
    v_add_u32 v21, 120864, v5
    v_mul_u32_u24 v4, 36896, v4
    v_add_u32 v3, 84032, v3
    v_add_u32 v22, v3, v4
    s_waitcnt lgkmcnt(0)
    global_load_dwordx4 v[32:35], v64, s[4:5]
    global_load_dwordx4 v[36:39], v64, s[4:5] offset:1024
    s_getpc_b64 s[68:69]
L_PC:
    s_lshr_b32 s66, s2, 3
    s_lshl_b32 s66, s66, 2
    s_add_u32 s66, s66, s3
    s_lshl_b32 s66, s66, 8
    v_lshl_add_u32 v65, v0, 7, s66
    v_min_u32 v65, L_END-L_PC, v65
    s_mov_b64 exec, 3
    global_load_dword v66, v65, s[68:69]
    s_mov_b64 exec, -1
    s_load_dword s60, s[34:35], 0
    s_mov_b32 s56, s34
    s_mov_b32 s57, s35
    s_mov_b32 s58, 33554432
    s_mov_b32 s59, 0x20000
    s_barrier
    v_and_b32 v3, 3, v0
    v_lshlrev_b32 v3, 4, v3
    v_lshl_add_u32 v3, v6, 6, v3
    v_add_u32 v60, 163296, v3
    s_lshl_b32 s66, s3, 4
    s_add_u32 s66, s66, 163296
    v_lshl_add_u32 v62, v6, 6, s66
    v_lshrrev_b32 v3, 3, v7
    v_lshlrev_b32 v3, 18, v3
    v_lshl_add_u32 v3, v6, 16, v3
    v_and_b32 v4, 7, v7
    v_lshl_add_u32 v61, v4, 4, v3
    s_lshl_b32 s12, s3, 19
    s_lshl_b32 s66, s64, 7
    s_add_u32 s12, s12, s66
    s_add_u32 s12, s12, 262144
    s_add_u32 s13, s12, 32768
    s_lshl_b32 s14, s64, 6
    s_add_u32 s14, s14, 4096
    s_cmp_eq_u32 s3, 0
    s_cselect_b32 s66, 0, 1073741824
    v_lshl_add_u32 v63, v6, 4, s66
    s_mul_i32 s66, s75, 96
    v_mul_u32_u24 v3, 3072, v2
    v_lshl_add_u32 v3, v1, 1, v3
    v_add_u32 v23, s66, v3
    v_bfe_u32 v3, v0, 4, 1
    v_mul_u32_u24 v3, 3072, v3
    v_lshl_add_u32 v3, v7, 1, v3
    s_add_u32 s66, s66, 64
    v_add_u32 v24, s66, v3
    v_mov_b32 v29, 163168
    v_mov_b32 v7, 1
    s_mov_b32 s77, 0x3f803f80
    v_mov_b32 v116, s77
    v_mov_b32 v117, s77
    v_mov_b32 v118, s77
    v_mov_b32 v119, s77
    s_lshl_b32 s66, s74, 9
    s_add_u32 s66, s66, 148512
    v_lshl_add_u32 v31, v1, 3, s66
    s_mul_i32 s66, s63, 6
    s_mul_i32 s67, s75, 3
    s_add_u32 s66, s66, s67
    s_cmp_le_u32 s66, 84
    s_cselect_b32 s67, 0, 1073741824
    v_add_u32 v25, s67, v27
    s_cmp_le_u32 s66, 83
    s_cselect_b32 s67, 0, 1073741824
    v_add_u32 v26, s67, v27
    s_lshl_b32 s67, s62, 2
    s_lshl_b32 s68, s74, 1
    s_add_u32 s67, s67, s68
    s_mul_i32 s67, s67, 86
    s_add_u32 s66, s66, s67
    s_lshl_b32 s66, s66, 10
    s_add_u32 s70, s66, 4456448
    s_add_u32 s71, s70, 88064
    v_bfe_u32 v3, v0, 2, 2
    v_lshl_add_u32 v3, v2, 2, v3
    v_bfe_u32 v4, v3, 1, 1
    v_lshlrev_b32 v4, 6, v4
    v_lshl_add_u32 v3, v3, 7, v4
    v_bfe_u32 v4, v0, 4, 1
    v_lshl_add_u32 v3, v4, 5, v3
    v_and_b32 v4, 3, v0
    v_lshl_add_u32 v3, v4, 3, v3
    s_lshl_b32 s66, s74, 6
    v_xor_b32 v4, s66, v3
    s_mul_i32 s66, s75, 17408
    s_add_u32 s66, s66, 8192
    v_add_u32 v14, s66, v4
    s_lshl_b32 s66, s75, 6
    v_xor_b32 v3, s66, v3
    v_xor_b32 v4, 64, v3
    s_lshl_b32 s66, s75, 13
    s_add_u32 s66, s66, 34816
    s_mul_i32 s67, s75, 6144
    s_add_u32 s67, s67, 83968
    s_lshl_b32 s68, s75, 11
    s_add_u32 s68, s68, 145440
    v_add_u32 v8, s66, v3
    v_add_u32 v9, s66, v4
    v_add_u32 v10, s67, v3
    v_add_u32 v11, s67, v4
    v_add_u32 v12, s68, v3
    v_add_u32 v13, s68, v4
    s_lshl_b32 s66, s65, 16
    s_lshl_b32 s67, s74, 15
    s_add_u32 s66, s66, s67
    s_lshl_b32 s67, s100, 7
    s_add_u32 s66, s66, s67
    s_lshl_b32 s67, s75, 6
    s_add_u32 s66, s66, s67
    v_lshlrev_b32 v3, 10, v1
    v_lshl_add_u32 v3, v2, 4, v3
    v_add_u32 v15, s66, v3
    s_mov_b32 s15, s66
    s_lshl_b32 s66, s75, 2
    s_add_u32 s66, s66, 163168
    v_mov_b32 v28, s66
    v_lshrrev_b32 v3, 3, v0
    v_and_b32 v4, 7, v0
    v_bfe_u32 v5, v0, 4, 1
    v_lshlrev_b32 v5, 2, v5
    v_xor_b32 v4, v4, v5
    v_lshlrev_b32 v4, 4, v4
    v_lshl_add_u32 v30, v3, 10, v4
    s_waitcnt vmcnt(2)
    v_dot2_f32_bf16 v1, v32, s77, 0
    s_waitcnt vmcnt(1)
    v_dot2_f32_bf16 v2, v36, s77, 0
    v_dot2_f32_bf16 v1, v33, s77, v1
    v_dot2_f32_bf16 v2, v37, s77, v2
    v_dot2_f32_bf16 v1, v34, s77, v1
    v_dot2_f32_bf16 v2, v38, s77, v2
    v_dot2_f32_bf16 v1, v35, s77, v1
    v_dot2_f32_bf16 v2, v39, s77, v2
    v_lshlrev_b32 v40, 16, v32
    v_and_b32 v41, 0xffff0000, v32
    v_lshlrev_b32 v42, 16, v33
    v_add_f32_dpp v1, v1, v1 quad_perm:[1,0,3,2] row_mask:0xf bank_mask:0xf
    v_add_f32_dpp v2, v2, v2 quad_perm:[1,0,3,2] row_mask:0xf bank_mask:0xf
    v_and_b32 v43, 0xffff0000, v33
    v_lshlrev_b32 v44, 16, v34
    v_add_f32_dpp v1, v1, v1 quad_perm:[2,3,0,1] row_mask:0xf bank_mask:0xf
    v_add_f32_dpp v2, v2, v2 quad_perm:[2,3,0,1] row_mask:0xf bank_mask:0xf
    v_and_b32 v45, 0xffff0000, v34
    v_lshlrev_b32 v46, 16, v35
    v_add_f32_dpp v1, v1, v1 row_half_mirror row_mask:0xf bank_mask:0xf
    v_add_f32_dpp v2, v2, v2 row_half_mirror row_mask:0xf bank_mask:0xf
    v_and_b32 v47, 0xffff0000, v35
    v_lshlrev_b32 v48, 16, v36
    v_add_f32_dpp v1, v1, v1 row_mirror row_mask:0xf bank_mask:0xf
    v_add_f32_dpp v2, v2, v2 row_mirror row_mask:0xf bank_mask:0xf
    v_and_b32 v49, 0xffff0000, v36
    v_lshlrev_b32 v50, 16, v37
    v_and_b32 v51, 0xffff0000, v37
    v_lshlrev_b32 v52, 16, v38
    v_and_b32 v53, 0xffff0000, v38
    v_lshlrev_b32 v54, 16, v39
    v_and_b32 v55, 0xffff0000, v39
    v_mul_f32 v56, 0x3c000000, v1
    v_mul_f32 v58, 0x3c000000, v2
    v_pk_add_f32 v[40:41], v[40:41], v[56:57] op_sel_hi:[1,0] neg_lo:[0,1] neg_hi:[0,1]
    v_pk_add_f32 v[48:49], v[48:49], v[58:59] op_sel_hi:[1,0] neg_lo:[0,1] neg_hi:[0,1]
    v_pk_add_f32 v[42:43], v[42:43], v[56:57] op_sel_hi:[1,0] neg_lo:[0,1] neg_hi:[0,1]
    v_pk_add_f32 v[50:51], v[50:51], v[58:59] op_sel_hi:[1,0] neg_lo:[0,1] neg_hi:[0,1]
    v_pk_add_f32 v[44:45], v[44:45], v[56:57] op_sel_hi:[1,0] neg_lo:[0,1] neg_hi:[0,1]
    v_pk_add_f32 v[52:53], v[52:53], v[58:59] op_sel_hi:[1,0] neg_lo:[0,1] neg_hi:[0,1]
    v_pk_add_f32 v[46:47], v[46:47], v[56:57] op_sel_hi:[1,0] neg_lo:[0,1] neg_hi:[0,1]
    v_pk_add_f32 v[54:55], v[54:55], v[58:59] op_sel_hi:[1,0] neg_lo:[0,1] neg_hi:[0,1]
    v_pk_mul_f32 v[2:3], v[40:41], v[40:41]
    v_pk_mul_f32 v[4:5], v[48:49], v[48:49]
    v_pk_fma_f32 v[2:3], v[42:43], v[42:43], v[2:3]
    v_pk_fma_f32 v[4:5], v[50:51], v[50:51], v[4:5]
    v_pk_fma_f32 v[2:3], v[44:45], v[44:45], v[2:3]
    v_pk_fma_f32 v[4:5], v[52:53], v[52:53], v[4:5]
    v_pk_fma_f32 v[2:3], v[46:47], v[46:47], v[2:3]
    v_pk_fma_f32 v[4:5], v[54:55], v[54:55], v[4:5]
    v_add_f32 v57, v2, v3
    v_add_f32 v59, v4, v5
    s_nop 0
    v_add_f32_dpp v57, v57, v57 quad_perm:[1,0,3,2] row_mask:0xf bank_mask:0xf
    v_add_f32_dpp v59, v59, v59 quad_perm:[1,0,3,2] row_mask:0xf bank_mask:0xf
    s_nop 0
    v_add_f32_dpp v57, v57, v57 quad_perm:[2,3,0,1] row_mask:0xf bank_mask:0xf
    v_add_f32_dpp v59, v59, v59 quad_perm:[2,3,0,1] row_mask:0xf bank_mask:0xf
    s_nop 0
    v_add_f32_dpp v57, v57, v57 row_half_mirror row_mask:0xf bank_mask:0xf
    v_add_f32_dpp v59, v59, v59 row_half_mirror row_mask:0xf bank_mask:0xf
    s_nop 0
    v_add_f32_dpp v57, v57, v57 row_mirror row_mask:0xf bank_mask:0xf
    v_add_f32_dpp v59, v59, v59 row_mirror row_mask:0xf bank_mask:0xf
    s_mov_b32 exec_lo, 0x10001
    s_mov_b32 exec_hi, 0x10001
    ds_write_b128 v62, v[56:59]
    s_mov_b64 exec, 1
    ds_add_u32 v29, v7 offset:48
    s_mov_b64 exec, -1
    s_mov_b32 s79, 524288
SPIN_1:
    ds_read_b32 v1, v29 offset:48
    s_waitcnt lgkmcnt(0)
    v_readfirstlane_b32 s78, v1
    s_cmp_ge_u32 s78, 4
    s_cbranch_scc1 SPINX_2
    s_sub_u32 s79, s79, 1
    s_cmp_lg_u32 s79, 0
    s_cbranch_scc1 SPIN_1
SPINX_2:
    ds_read_b128 v[32:35], v60
    v_mov_b32 v68, 0x3727c5ac
    v_mov_b32 v70, 0x3727c5ac
    s_waitcnt lgkmcnt(0)
    v_add_f32_dpp v36, v32, v32 quad_perm:[1,0,3,2] row_mask:0xf bank_mask:0xf
    v_add_f32_dpp v37, v34, v34 quad_perm:[1,0,3,2] row_mask:0xf bank_mask:0xf
    s_nop 0
    v_add_f32_dpp v36, v36, v36 quad_perm:[2,3,0,1] row_mask:0xf bank_mask:0xf
    v_add_f32_dpp v37, v37, v37 quad_perm:[2,3,0,1] row_mask:0xf bank_mask:0xf
    v_mul_f32 v36, 0x3e800000, v36
    v_mul_f32 v37, 0x3e800000, v37
    v_sub_f32 v38, v32, v36
    v_sub_f32 v39, v34, v37
    v_mul_f32 v38, v38, v38
    v_mul_f32 v39, v39, v39
    v_fmac_f32 v33, 0x43000000, v38
    v_fmac_f32 v35, 0x43000000, v39
    v_sub_f32 v72, v56, v36
    v_sub_f32 v74, v58, v37
    v_add_f32_dpp v38, v33, v33 quad_perm:[1,0,3,2] row_mask:0xf bank_mask:0xf
    v_add_f32_dpp v39, v35, v35 quad_perm:[1,0,3,2] row_mask:0xf bank_mask:0xf
    v_cvt_pk_bf16_f32 v56, -v36, -v36
    v_cvt_pk_bf16_f32 v58, -v37, -v37
    v_add_f32_dpp v38, v38, v38 quad_perm:[2,3,0,1] row_mask:0xf bank_mask:0xf
    v_add_f32_dpp v39, v39, v39 quad_perm:[2,3,0,1] row_mask:0xf bank_mask:0xf
    v_fmac_f32 v68, 0x3b000000, v38
    v_fmac_f32 v70, 0x3b000000, v39
    v_rsq_f32 v68, v68
    v_rsq_f32 v70, v70
    v_mul_f32 v72, v72, v68
    v_mul_f32 v74, v74, v70
    v_pk_fma_f32 v[40:41], v[40:41], v[68:69], v[72:73] op_sel_hi:[1,0,0]
    v_pk_fma_f32 v[48:49], v[48:49], v[70:71], v[74:75] op_sel_hi:[1,0,0]
    v_pk_fma_f32 v[42:43], v[42:43], v[68:69], v[72:73] op_sel_hi:[1,0,0]
    v_pk_fma_f32 v[50:51], v[50:51], v[70:71], v[74:75] op_sel_hi:[1,0,0]
    v_pk_fma_f32 v[44:45], v[44:45], v[68:69], v[72:73] op_sel_hi:[1,0,0]
    v_pk_fma_f32 v[52:53], v[52:53], v[70:71], v[74:75] op_sel_hi:[1,0,0]
    v_pk_fma_f32 v[46:47], v[46:47], v[68:69], v[72:73] op_sel_hi:[1,0,0]
    v_pk_fma_f32 v[54:55], v[54:55], v[70:71], v[74:75] op_sel_hi:[1,0,0]
    v_cvt_pk_bf16_f32 v76, v40, v48
    v_cvt_pk_bf16_f32 v77, v42, v50
    v_cvt_pk_bf16_f32 v78, v44, v52
    v_cvt_pk_bf16_f32 v79, v46, v54
    v_cvt_pk_bf16_f32 v80, v41, v49
    v_cvt_pk_bf16_f32 v81, v43, v51
    v_cvt_pk_bf16_f32 v82, v45, v53
    v_cvt_pk_bf16_f32 v83, v47, v55
    v_mul_f32 v57, v68, v68
    v_mul_f32 v59, v70, v70
    v_permlane32_swap_b32 v76, v78
    v_permlane32_swap_b32 v80, v82
    v_permlane32_swap_b32 v77, v79
    v_permlane32_swap_b32 v81, v83
    s_nop 0
    v_permlane16_swap_b32 v76, v77
    v_permlane16_swap_b32 v78, v79
    v_permlane16_swap_b32 v80, v81
    v_permlane16_swap_b32 v82, v83
    buffer_store_dwordx4 v[76:79], v61, s[56:59], s12 offen sc1
    buffer_store_dwordx4 v[80:83], v61, s[56:59], s13 offen sc1
    s_mov_b32 exec_lo, 0x10001
    s_mov_b32 exec_hi, 0x10001
    buffer_store_dwordx4 v[56:59], v63, s[56:59], s14 offen sc1
    s_mov_b64 exec, -1
    s_and_b32 s101, s100, 0
    s_mul_i32 s101, s101, 688
    s_bfe_u32 s72, s2, 0x20003
    s_mul_i32 s72, s72, 0
    s_add_u32 s101, s101, s72
    s_and_b32 s72, s2, 7
    s_mul_i32 s72, s72, 0
    s_add_u32 s101, s101, s72
    s_lshr_b32 s101, s101, 4
    s_cmp_ge_u32 s101, 43
    s_cselect_b32 s72, 43, 0
    s_sub_u32 s101, s101, s72
    s_lshl_b32 s7, s65, 1
    s_add_u32 s7, s7, s74
    s_mul_i32 s7, s7, 86
    s_mul_i32 s66, s75, 43
    s_add_u32 s7, s7, s66
    s_lshl_b32 s7, s7, 10
    s_add_u32 s7, s7, 4456448
    s_add_u32 s8, s7, 44032
    s_lshl_b32 s66, s101, 10
    s_add_u32 s6, s7, s66
    s_lshl_b32 s9, s62, 1
    s_add_u32 s9, s9, s74
    s_lshl_b32 s9, s9, 10
    s_add_u32 s9, s9, 10485760
    s_lshl_b32 s11, s63, 1
    s_add_u32 s11, s11, s75
    s_lshl_b32 s10, s65, 1
    s_add_u32 s10, s10, s75
    s_lshl_b32 s10, s10, 2
    s_lshl_b32 s66, s100, 1
    s_add_u32 s66, s66, s74
    s_and_b32 s66, s66, 3
    s_add_u32 s10, s10, s66
    s_lshl_b32 s10, s10, 7
    s_add_u32 s10, s10, 10485760
    s_lshl_b32 s36, s3, 12
    s_mul_i32 s37, s3, 3072
    s_lshl_b32 s38, s3, 10
    s_mul_i32 s40, s75, 704512
    s_lshl_b32 s66, s74, 13
    s_add_u32 s40, s40, s66
    s_lshl_b32 s66, s100, 7
    s_add_u32 s40, s40, s66
    s_add_u32 s41, s40, 704512
    s_add_u32 s66, s101, 16
    s_cmp_ge_u32 s66, 43
    s_cselect_b32 s67, 43, 0
    s_sub_u32 s66, s66, s67
    s_lshl_b32 s66, s66, 14
    s_add_u32 s39, s40, s66
    s_mov_b32 s48, s28
    s_mov_b32 s49, s29
    s_mov_b32 s50, 1409024
    s_mov_b32 s51, 0x20000
    s_mov_b32 s52, s30
    s_mov_b32 s53, s31
    s_mov_b32 s54, 0x200000
    s_mov_b32 s55, 0x20000
    s_mul_i32 s44, s63, 6144
    s_mul_i32 s66, s62, 192
    s_add_u32 s44, s44, s66
    s_add_u32 s44, s44, 32768
    s_cmp_eq_u32 s74, 0
    s_cselect_b32 s44, s44, 1073741824
    s_waitcnt lgkmcnt(0)
    s_mul_i32 s60, s60, 0x9E3779B1
    s_add_u32 s60, s60, 0x7F4A7C15
    s_mov_b32 s61, s60
    s_barrier
    ds_read_b128 v[132:135], v16 offset:0
    ds_read_b64_tr_b16 v[120:121], v20 offset:0
    ds_read_b64_tr_b16 v[122:123], v20 offset:768
    ds_read_b128 v[136:139], v16 offset:4096
    ds_read_b64_tr_b16 v[124:125], v22 offset:0
    ds_read_b64_tr_b16 v[126:127], v22 offset:768
    ds_read_b64_tr_b16 v[128:129], v21 offset:0
    ds_read_b64_tr_b16 v[130:131], v21 offset:768
    s_waitcnt lgkmcnt(5)
    v_mfma_f32_32x32x16_bf16 v[160:175], v[120:123], v[132:135], 0
    ds_read_b128 v[152:155], v17 offset:0
    ds_read_b64_tr_b16 v[140:141], v20 offset:3072
    s_waitcnt lgkmcnt(6)
    v_mfma_f32_32x32x16_bf16 v[176:191], v[120:123], v[136:139], 0
    ds_read_b64_tr_b16 v[142:143], v20 offset:3840
    v_mfma_f32_32x32x16_bf16 v[68:83], v[116:119], v[120:123], 0
    s_waitcnt lgkmcnt(5)
    v_mfma_f32_32x32x16_bf16 v[192:207], v[124:127], v[132:135], 0
    ds_read_b128 v[156:159], v17 offset:4096
    ds_read_b64_tr_b16 v[144:145], v22 offset:3072
    v_mfma_f32_32x32x16_bf16 v[208:223], v[124:127], v[136:139], 0
    ds_read_b64_tr_b16 v[146:147], v22 offset:3840
    v_mfma_f32_32x32x16_bf16 v[84:99], v[116:119], v[124:127], 0
    s_waitcnt lgkmcnt(6)
    v_mfma_f32_32x32x16_bf16 v[224:239], v[128:131], v[132:135], 0
    ds_read_b64_tr_b16 v[148:149], v21 offset:3072
    v_mfma_f32_32x32x16_bf16 v[240:255], v[128:131], v[136:139], 0
    ds_read_b64_tr_b16 v[150:151], v21 offset:3840
    v_mfma_f32_32x32x16_bf16 v[100:115], v[116:119], v[128:131], 0
    s_waitcnt lgkmcnt(5)
    v_mfma_f32_32x32x16_bf16 v[160:175], v[140:143], v[152:155], v[160:175]
    ds_read_b128 v[132:135], v18 offset:0
    ds_read_b64_tr_b16 v[120:121], v20 offset:6144
    s_waitcnt lgkmcnt(6)
    v_mfma_f32_32x32x16_bf16 v[176:191], v[140:143], v[156:159], v[176:191]
    ds_read_b64_tr_b16 v[122:123], v20 offset:6912
    v_mfma_f32_32x32x16_bf16 v[68:83], v[116:119], v[140:143], v[68:83]
    s_waitcnt lgkmcnt(5)
    v_mfma_f32_32x32x16_bf16 v[192:207], v[144:147], v[152:155], v[192:207]
    ds_read_b128 v[136:139], v18 offset:4096
    ds_read_b64_tr_b16 v[124:125], v22 offset:6144
    v_mfma_f32_32x32x16_bf16 v[208:223], v[144:147], v[156:159], v[208:223]
    ds_read_b64_tr_b16 v[126:127], v22 offset:6912
    v_mfma_f32_32x32x16_bf16 v[84:99], v[116:119], v[144:147], v[84:99]
    s_waitcnt lgkmcnt(6)
    v_mfma_f32_32x32x16_bf16 v[224:239], v[148:151], v[152:155], v[224:239]
    ds_read_b64_tr_b16 v[128:129], v21 offset:6144
    v_mfma_f32_32x32x16_bf16 v[240:255], v[148:151], v[156:159], v[240:255]
    ds_read_b64_tr_b16 v[130:131], v21 offset:6912
    v_mfma_f32_32x32x16_bf16 v[100:115], v[116:119], v[148:151], v[100:115]
    s_waitcnt lgkmcnt(5)
    v_mfma_f32_32x32x16_bf16 v[160:175], v[120:123], v[132:135], v[160:175]
    ds_read_b128 v[152:155], v19 offset:0
    ds_read_b64_tr_b16 v[140:141], v20 offset:9216
    s_waitcnt lgkmcnt(6)
    v_mfma_f32_32x32x16_bf16 v[176:191], v[120:123], v[136:139], v[176:191]
    ds_read_b64_tr_b16 v[142:143], v20 offset:9984
    s_waitcnt lgkmcnt(5)
    v_mfma_f32_32x32x16_bf16 v[192:207], v[124:127], v[132:135], v[192:207]
    ds_read_b128 v[156:159], v19 offset:4096
    ds_read_b64_tr_b16 v[144:145], v22 offset:9216
    v_mfma_f32_32x32x16_bf16 v[208:223], v[124:127], v[136:139], v[208:223]
    ds_read_b64_tr_b16 v[146:147], v22 offset:9984
    v_permlane32_swap_b32 v68, v100
    s_waitcnt lgkmcnt(6)
    v_mfma_f32_32x32x16_bf16 v[224:239], v[128:131], v[132:135], v[224:239]
    ds_read_b64_tr_b16 v[148:149], v21 offset:9216
    v_cvt_pk_bf16_f32 v68, v68, v84
    v_mfma_f32_32x32x16_bf16 v[240:255], v[128:131], v[136:139], v[240:255]
    ds_read_b64_tr_b16 v[150:151], v21 offset:9984
    buffer_store_short v68, v23, s[56:59], s44 offen sc1
    s_waitcnt lgkmcnt(5)
    v_mfma_f32_32x32x16_bf16 v[160:175], v[140:143], v[152:155], v[160:175]
    s_mov_b32 exec_hi, 0
    buffer_store_short_d16_hi v68, v24, s[56:59], s44 offen sc1
    s_mov_b32 exec_hi, -1
    s_waitcnt lgkmcnt(4)
    v_mfma_f32_32x32x16_bf16 v[176:191], v[140:143], v[156:159], v[176:191]
    s_waitcnt lgkmcnt(2)
    v_mfma_f32_32x32x16_bf16 v[192:207], v[144:147], v[152:155], v[192:207]
    s_waitcnt lgkmcnt(0)
    s_barrier
    ds_read_b128 v[132:135], v16 offset:16384
    ds_read_b64_tr_b16 v[120:121], v20 offset:12288
    v_mfma_f32_32x32x16_bf16 v[208:223], v[144:147], v[156:159], v[208:223]
    ds_read_b64_tr_b16 v[122:123], v20 offset:13056
    ds_read_b128 v[136:139], v16 offset:20480
    v_mfma_f32_32x32x16_bf16 v[224:239], v[148:151], v[152:155], v[224:239]
    ds_read_b64_tr_b16 v[124:125], v22 offset:12288
    ds_read_b64_tr_b16 v[126:127], v22 offset:13056
    v_mfma_f32_32x32x16_bf16 v[240:255], v[148:151], v[156:159], v[240:255]
    ds_read_b64_tr_b16 v[128:129], v21 offset:12288
    ds_read_b64_tr_b16 v[130:131], v21 offset:13056
    s_waitcnt lgkmcnt(5)
    v_mfma_f32_32x32x16_bf16 v[160:175], v[120:123], v[132:135], v[160:175]
    ds_read_b128 v[152:155], v17 offset:16384
    ds_read_b64_tr_b16 v[140:141], v20 offset:15360
    s_waitcnt lgkmcnt(6)
    v_mfma_f32_32x32x16_bf16 v[176:191], v[120:123], v[136:139], v[176:191]
    ds_read_b64_tr_b16 v[142:143], v20 offset:16128
    s_waitcnt lgkmcnt(5)
    v_mfma_f32_32x32x16_bf16 v[192:207], v[124:127], v[132:135], v[192:207]
    ds_read_b128 v[156:159], v17 offset:20480
    ds_read_b64_tr_b16 v[144:145], v22 offset:15360
    v_mfma_f32_32x32x16_bf16 v[208:223], v[124:127], v[136:139], v[208:223]
    ds_read_b64_tr_b16 v[146:147], v22 offset:16128
    s_waitcnt lgkmcnt(6)
    v_mfma_f32_32x32x16_bf16 v[224:239], v[128:131], v[132:135], v[224:239]
    ds_read_b64_tr_b16 v[148:149], v21 offset:15360
    v_mfma_f32_32x32x16_bf16 v[240:255], v[128:131], v[136:139], v[240:255]
    ds_read_b64_tr_b16 v[150:151], v21 offset:16128
    s_waitcnt lgkmcnt(5)
    v_mfma_f32_32x32x16_bf16 v[160:175], v[140:143], v[152:155], v[160:175]
    ds_read_b128 v[132:135], v18 offset:16384
    ds_read_b64_tr_b16 v[120:121], v20 offset:18432
    s_waitcnt lgkmcnt(6)
    v_mfma_f32_32x32x16_bf16 v[176:191], v[140:143], v[156:159], v[176:191]
    ds_read_b64_tr_b16 v[122:123], v20 offset:19200
    s_waitcnt lgkmcnt(5)
    v_mfma_f32_32x32x16_bf16 v[192:207], v[144:147], v[152:155], v[192:207]
    ds_read_b128 v[136:139], v18 offset:20480
    ds_read_b64_tr_b16 v[124:125], v22 offset:18432
    v_mfma_f32_32x32x16_bf16 v[208:223], v[144:147], v[156:159], v[208:223]
    ds_read_b64_tr_b16 v[126:127], v22 offset:19200
    s_waitcnt lgkmcnt(6)
    v_mfma_f32_32x32x16_bf16 v[224:239], v[148:151], v[152:155], v[224:239]
    ds_read_b64_tr_b16 v[128:129], v21 offset:18432
    v_mfma_f32_32x32x16_bf16 v[240:255], v[148:151], v[156:159], v[240:255]
    ds_read_b64_tr_b16 v[130:131], v21 offset:19200
    s_waitcnt lgkmcnt(5)
    v_mfma_f32_32x32x16_bf16 v[160:175], v[120:123], v[132:135], v[160:175]
    ds_read_b128 v[152:155], v19 offset:16384
    ds_read_b64_tr_b16 v[140:141], v20 offset:21504
    s_waitcnt lgkmcnt(6)
    v_mfma_f32_32x32x16_bf16 v[176:191], v[120:123], v[136:139], v[176:191]
    ds_read_b64_tr_b16 v[142:143], v20 offset:22272
    s_waitcnt lgkmcnt(5)
    v_mfma_f32_32x32x16_bf16 v[192:207], v[124:127], v[132:135], v[192:207]
    ds_read_b128 v[156:159], v19 offset:20480
    ds_read_b64_tr_b16 v[144:145], v22 offset:21504
    v_mfma_f32_32x32x16_bf16 v[208:223], v[124:127], v[136:139], v[208:223]
    ds_read_b64_tr_b16 v[146:147], v22 offset:22272
    s_waitcnt lgkmcnt(6)
    v_mfma_f32_32x32x16_bf16 v[224:239], v[128:131], v[132:135], v[224:239]
    ds_read_b64_tr_b16 v[148:149], v21 offset:21504
    v_mfma_f32_32x32x16_bf16 v[240:255], v[128:131], v[136:139], v[240:255]
    ds_read_b64_tr_b16 v[150:151], v21 offset:22272
    s_waitcnt lgkmcnt(5)
    v_mfma_f32_32x32x16_bf16 v[160:175], v[140:143], v[152:155], v[160:175]
    s_waitcnt lgkmcnt(4)
    v_mfma_f32_32x32x16_bf16 v[176:191], v[140:143], v[156:159], v[176:191]
    s_waitcnt vmcnt(0)
    s_waitcnt lgkmcnt(2)
    v_mfma_f32_32x32x16_bf16 v[192:207], v[144:147], v[152:155], v[192:207]
    s_waitcnt lgkmcnt(0)
    s_barrier
    ds_read_b128 v[132:135], v16 offset:32768
    ds_read_b64_tr_b16 v[120:121], v20 offset:24576
    v_mfma_f32_32x32x16_bf16 v[208:223], v[144:147], v[156:159], v[208:223]
    ds_read_b64_tr_b16 v[122:123], v20 offset:25344
    ds_read_b128 v[136:139], v16 offset:36864
    v_mfma_f32_32x32x16_bf16 v[224:239], v[148:151], v[152:155], v[224:239]
    ds_read_b64_tr_b16 v[124:125], v22 offset:24576
    ds_read_b64_tr_b16 v[126:127], v22 offset:25344
    v_mfma_f32_32x32x16_bf16 v[240:255], v[148:151], v[156:159], v[240:255]
    ds_read_b64_tr_b16 v[128:129], v21 offset:24576
    ds_read_b64_tr_b16 v[130:131], v21 offset:25344
    s_waitcnt lgkmcnt(5)
    v_mfma_f32_32x32x16_bf16 v[160:175], v[120:123], v[132:135], v[160:175]
    ds_read_b128 v[152:155], v17 offset:32768
    ds_read_b64_tr_b16 v[140:141], v20 offset:27648
    s_waitcnt lgkmcnt(6)
    v_mfma_f32_32x32x16_bf16 v[176:191], v[120:123], v[136:139], v[176:191]
    ds_read_b64_tr_b16 v[142:143], v20 offset:28416
    s_waitcnt lgkmcnt(5)
    v_mfma_f32_32x32x16_bf16 v[192:207], v[124:127], v[132:135], v[192:207]
    ds_read_b128 v[156:159], v17 offset:36864
    ds_read_b64_tr_b16 v[144:145], v22 offset:27648
    v_mfma_f32_32x32x16_bf16 v[208:223], v[124:127], v[136:139], v[208:223]
    ds_read_b64_tr_b16 v[146:147], v22 offset:28416
    s_waitcnt lgkmcnt(6)
    v_mfma_f32_32x32x16_bf16 v[224:239], v[128:131], v[132:135], v[224:239]
    ds_read_b64_tr_b16 v[148:149], v21 offset:27648
    v_mfma_f32_32x32x16_bf16 v[240:255], v[128:131], v[136:139], v[240:255]
    ds_read_b64_tr_b16 v[150:151], v21 offset:28416
    s_waitcnt lgkmcnt(5)
    v_mfma_f32_32x32x16_bf16 v[160:175], v[140:143], v[152:155], v[160:175]
    ds_read_b128 v[132:135], v18 offset:32768
    ds_read_b64_tr_b16 v[120:121], v20 offset:30720
    s_waitcnt lgkmcnt(6)
    v_mfma_f32_32x32x16_bf16 v[176:191], v[140:143], v[156:159], v[176:191]
    ds_read_b64_tr_b16 v[122:123], v20 offset:31488
    s_waitcnt lgkmcnt(5)
    v_mfma_f32_32x32x16_bf16 v[192:207], v[144:147], v[152:155], v[192:207]
    ds_read_b128 v[136:139], v18 offset:36864
    ds_read_b64_tr_b16 v[124:125], v22 offset:30720
    v_mfma_f32_32x32x16_bf16 v[208:223], v[144:147], v[156:159], v[208:223]
    ds_read_b64_tr_b16 v[126:127], v22 offset:31488
    s_waitcnt lgkmcnt(6)
    v_mfma_f32_32x32x16_bf16 v[224:239], v[148:151], v[152:155], v[224:239]
    ds_read_b64_tr_b16 v[128:129], v21 offset:30720
    v_mfma_f32_32x32x16_bf16 v[240:255], v[148:151], v[156:159], v[240:255]
    ds_read_b64_tr_b16 v[130:131], v21 offset:31488
    s_waitcnt lgkmcnt(5)
    v_mfma_f32_32x32x16_bf16 v[160:175], v[120:123], v[132:135], v[160:175]
    ds_read_b128 v[152:155], v19 offset:32768
    ds_read_b64_tr_b16 v[140:141], v20 offset:33792
    s_waitcnt lgkmcnt(6)
    v_mfma_f32_32x32x16_bf16 v[176:191], v[120:123], v[136:139], v[176:191]
    ds_read_b64_tr_b16 v[142:143], v20 offset:34560
    s_waitcnt lgkmcnt(5)
    v_mfma_f32_32x32x16_bf16 v[192:207], v[124:127], v[132:135], v[192:207]
    ds_read_b128 v[156:159], v19 offset:36864
    ds_read_b64_tr_b16 v[144:145], v22 offset:33792
    v_mfma_f32_32x32x16_bf16 v[208:223], v[124:127], v[136:139], v[208:223]
    ds_read_b64_tr_b16 v[146:147], v22 offset:34560
    s_waitcnt lgkmcnt(6)
    v_mfma_f32_32x32x16_bf16 v[224:239], v[128:131], v[132:135], v[224:239]
    ds_read_b64_tr_b16 v[148:149], v21 offset:33792
    v_mfma_f32_32x32x16_bf16 v[240:255], v[128:131], v[136:139], v[240:255]
    ds_read_b64_tr_b16 v[150:151], v21 offset:34560
    s_waitcnt lgkmcnt(5)
    v_mfma_f32_32x32x16_bf16 v[160:175], v[140:143], v[152:155], v[160:175]
    s_waitcnt lgkmcnt(4)
    v_mfma_f32_32x32x16_bf16 v[176:191], v[140:143], v[156:159], v[176:191]
    s_waitcnt lgkmcnt(2)
    v_mfma_f32_32x32x16_bf16 v[192:207], v[144:147], v[152:155], v[192:207]
    s_waitcnt lgkmcnt(0)
    s_barrier
    ds_read_b128 v[132:135], v16 offset:0
    ds_read_b64_tr_b16 v[120:121], v20 offset:0
    v_mfma_f32_32x32x16_bf16 v[208:223], v[144:147], v[156:159], v[208:223]
    ds_read_b64_tr_b16 v[122:123], v20 offset:768
    ds_read_b128 v[136:139], v16 offset:4096
    v_mfma_f32_32x32x16_bf16 v[224:239], v[148:151], v[152:155], v[224:239]
    ds_read_b64_tr_b16 v[124:125], v22 offset:0
    ds_read_b64_tr_b16 v[126:127], v22 offset:768
    v_mfma_f32_32x32x16_bf16 v[240:255], v[148:151], v[156:159], v[240:255]
    ds_read_b64_tr_b16 v[128:129], v21 offset:0
    ds_read_b64_tr_b16 v[130:131], v21 offset:768
    s_waitcnt lgkmcnt(5)
    v_mfma_f32_32x32x16_bf16 v[160:175], v[120:123], v[132:135], v[160:175]
    ds_read_b128 v[152:155], v17 offset:0
    ds_read_b64_tr_b16 v[140:141], v20 offset:3072
    s_waitcnt lgkmcnt(6)
    v_mfma_f32_32x32x16_bf16 v[176:191], v[120:123], v[136:139], v[176:191]
    ds_read_b64_tr_b16 v[142:143], v20 offset:3840
    s_waitcnt lgkmcnt(5)
    v_mfma_f32_32x32x16_bf16 v[192:207], v[124:127], v[132:135], v[192:207]
    s_mul_i32 s66, s2, 5504
    s_mul_i32 s67, s3, 1408
    s_add_u32 s66, s66, s67
    v_lshl_add_u32 v65, v0, 7, s66
    s_cmp_eq_u32 s3, 3
    s_cselect_b32 s67, 10, 11
    s_bfm_b64 exec, s67, 0
    global_load_dword v67, v65, s[28:29]
    s_mov_b64 exec, 1
    s_mov_b64 exec, -1
    ds_read_b128 v[156:159], v17 offset:4096
    ds_read_b64_tr_b16 v[144:145], v22 offset:3072
    v_mfma_f32_32x32x16_bf16 v[208:223], v[124:127], v[136:139], v[208:223]
    ds_read_b64_tr_b16 v[146:147], v22 offset:3840
    s_waitcnt lgkmcnt(6)
    v_mfma_f32_32x32x16_bf16 v[224:239], v[128:131], v[132:135], v[224:239]
    ds_read_b64_tr_b16 v[148:149], v21 offset:3072
    v_mfma_f32_32x32x16_bf16 v[240:255], v[128:131], v[136:139], v[240:255]
    ds_read_b64_tr_b16 v[150:151], v21 offset:3840
    s_waitcnt lgkmcnt(5)
    v_mfma_f32_32x32x16_bf16 v[160:175], v[140:143], v[152:155], v[160:175]
    ds_read_b128 v[132:135], v18 offset:0
    ds_read_b64_tr_b16 v[120:121], v20 offset:6144
    s_waitcnt lgkmcnt(6)
    v_mfma_f32_32x32x16_bf16 v[176:191], v[140:143], v[156:159], v[176:191]
    ds_read_b64_tr_b16 v[122:123], v20 offset:6912
    s_waitcnt lgkmcnt(5)
    v_mfma_f32_32x32x16_bf16 v[192:207], v[144:147], v[152:155], v[192:207]
    ds_read_b128 v[136:139], v18 offset:4096
    ds_read_b64_tr_b16 v[124:125], v22 offset:6144
    v_mfma_f32_32x32x16_bf16 v[208:223], v[144:147], v[156:159], v[208:223]
    ds_read_b64_tr_b16 v[126:127], v22 offset:6912
    s_waitcnt lgkmcnt(6)
    v_mfma_f32_32x32x16_bf16 v[224:239], v[148:151], v[152:155], v[224:239]
    ds_read_b64_tr_b16 v[128:129], v21 offset:6144
    v_mfma_f32_32x32x16_bf16 v[240:255], v[148:151], v[156:159], v[240:255]
    ds_read_b64_tr_b16 v[130:131], v21 offset:6912
    s_waitcnt lgkmcnt(5)
    v_mfma_f32_32x32x16_bf16 v[160:175], v[120:123], v[132:135], v[160:175]
    ds_read_b128 v[152:155], v19 offset:0
    ds_read_b64_tr_b16 v[140:141], v20 offset:9216
    s_waitcnt lgkmcnt(6)
    v_mfma_f32_32x32x16_bf16 v[176:191], v[120:123], v[136:139], v[176:191]
    ds_read_b64_tr_b16 v[142:143], v20 offset:9984
    s_waitcnt lgkmcnt(5)
    v_mfma_f32_32x32x16_bf16 v[192:207], v[124:127], v[132:135], v[192:207]
    ds_read_b128 v[156:159], v19 offset:4096
    ds_read_b64_tr_b16 v[144:145], v22 offset:9216
    v_mfma_f32_32x32x16_bf16 v[208:223], v[124:127], v[136:139], v[208:223]
    ds_read_b64_tr_b16 v[146:147], v22 offset:9984
    s_waitcnt lgkmcnt(6)
    v_mfma_f32_32x32x16_bf16 v[224:239], v[128:131], v[132:135], v[224:239]
    ds_read_b64_tr_b16 v[148:149], v21 offset:9216
    v_mfma_f32_32x32x16_bf16 v[240:255], v[128:131], v[136:139], v[240:255]
    ds_read_b64_tr_b16 v[150:151], v21 offset:9984
    s_waitcnt lgkmcnt(5)
    v_mfma_f32_32x32x16_bf16 v[160:175], v[140:143], v[152:155], v[160:175]
    s_waitcnt lgkmcnt(4)
    v_mfma_f32_32x32x16_bf16 v[176:191], v[140:143], v[156:159], v[176:191]
    s_waitcnt lgkmcnt(2)
    v_mfma_f32_32x32x16_bf16 v[192:207], v[144:147], v[152:155], v[192:207]
    s_waitcnt lgkmcnt(0)
    s_barrier
    ds_read_b128 v[132:135], v16 offset:16384
    ds_read_b64_tr_b16 v[120:121], v20 offset:12288
    v_mfma_f32_32x32x16_bf16 v[208:223], v[144:147], v[156:159], v[208:223]
    ds_read_b64_tr_b16 v[122:123], v20 offset:13056
    ds_read_b128 v[136:139], v16 offset:20480
    v_mfma_f32_32x32x16_bf16 v[224:239], v[148:151], v[152:155], v[224:239]
    ds_read_b64_tr_b16 v[124:125], v22 offset:12288
    ds_read_b64_tr_b16 v[126:127], v22 offset:13056
    v_mfma_f32_32x32x16_bf16 v[240:255], v[148:151], v[156:159], v[240:255]
    ds_read_b64_tr_b16 v[128:129], v21 offset:12288
    ds_read_b64_tr_b16 v[130:131], v21 offset:13056
    s_waitcnt lgkmcnt(5)
    v_mfma_f32_32x32x16_bf16 v[160:175], v[120:123], v[132:135], v[160:175]
    ds_read_b128 v[152:155], v17 offset:16384
    ds_read_b64_tr_b16 v[140:141], v20 offset:15360
    s_waitcnt lgkmcnt(6)
    v_mfma_f32_32x32x16_bf16 v[176:191], v[120:123], v[136:139], v[176:191]
    ds_read_b64_tr_b16 v[142:143], v20 offset:16128
    s_waitcnt lgkmcnt(5)
    v_mfma_f32_32x32x16_bf16 v[192:207], v[124:127], v[132:135], v[192:207]
    ds_read_b128 v[156:159], v17 offset:20480
    ds_read_b64_tr_b16 v[144:145], v22 offset:15360
    v_mfma_f32_32x32x16_bf16 v[208:223], v[124:127], v[136:139], v[208:223]
    ds_read_b64_tr_b16 v[146:147], v22 offset:16128
    s_waitcnt lgkmcnt(6)
    v_mfma_f32_32x32x16_bf16 v[224:239], v[128:131], v[132:135], v[224:239]
    ds_read_b64_tr_b16 v[148:149], v21 offset:15360
    v_mfma_f32_32x32x16_bf16 v[240:255], v[128:131], v[136:139], v[240:255]
    ds_read_b64_tr_b16 v[150:151], v21 offset:16128
    s_waitcnt lgkmcnt(5)
    v_mfma_f32_32x32x16_bf16 v[160:175], v[140:143], v[152:155], v[160:175]
    ds_read_b128 v[132:135], v18 offset:16384
    ds_read_b64_tr_b16 v[120:121], v20 offset:18432
    s_waitcnt lgkmcnt(6)
    v_mfma_f32_32x32x16_bf16 v[176:191], v[140:143], v[156:159], v[176:191]
    ds_read_b64_tr_b16 v[122:123], v20 offset:19200
    s_waitcnt lgkmcnt(5)
    v_mfma_f32_32x32x16_bf16 v[192:207], v[144:147], v[152:155], v[192:207]
    ds_read_b128 v[136:139], v18 offset:20480
    ds_read_b64_tr_b16 v[124:125], v22 offset:18432
    v_mfma_f32_32x32x16_bf16 v[208:223], v[144:147], v[156:159], v[208:223]
    ds_read_b64_tr_b16 v[126:127], v22 offset:19200
    s_waitcnt lgkmcnt(6)
    v_mfma_f32_32x32x16_bf16 v[224:239], v[148:151], v[152:155], v[224:239]
    ds_read_b64_tr_b16 v[128:129], v21 offset:18432
    v_mfma_f32_32x32x16_bf16 v[240:255], v[148:151], v[156:159], v[240:255]
    ds_read_b64_tr_b16 v[130:131], v21 offset:19200
    s_waitcnt lgkmcnt(5)
    v_mfma_f32_32x32x16_bf16 v[160:175], v[120:123], v[132:135], v[160:175]
    ds_read_b128 v[152:155], v19 offset:16384
    ds_read_b64_tr_b16 v[140:141], v20 offset:21504
    s_waitcnt lgkmcnt(6)
    v_mfma_f32_32x32x16_bf16 v[176:191], v[120:123], v[136:139], v[176:191]
    ds_read_b64_tr_b16 v[142:143], v20 offset:22272
    s_waitcnt lgkmcnt(5)
    v_mfma_f32_32x32x16_bf16 v[192:207], v[124:127], v[132:135], v[192:207]
    ds_read_b128 v[156:159], v19 offset:20480
    ds_read_b64_tr_b16 v[144:145], v22 offset:21504
    v_mfma_f32_32x32x16_bf16 v[208:223], v[124:127], v[136:139], v[208:223]
    ds_read_b64_tr_b16 v[146:147], v22 offset:22272
    s_waitcnt lgkmcnt(6)
    v_mfma_f32_32x32x16_bf16 v[224:239], v[128:131], v[132:135], v[224:239]
    ds_read_b64_tr_b16 v[148:149], v21 offset:21504
    v_mfma_f32_32x32x16_bf16 v[240:255], v[128:131], v[136:139], v[240:255]
    ds_read_b64_tr_b16 v[150:151], v21 offset:22272
    s_waitcnt lgkmcnt(5)
    v_mfma_f32_32x32x16_bf16 v[160:175], v[140:143], v[152:155], v[160:175]
    s_waitcnt lgkmcnt(4)
    v_mfma_f32_32x32x16_bf16 v[176:191], v[140:143], v[156:159], v[176:191]
    s_waitcnt lgkmcnt(2)
    v_mfma_f32_32x32x16_bf16 v[192:207], v[144:147], v[152:155], v[192:207]
    s_waitcnt lgkmcnt(0)
    s_barrier
    ds_read_b128 v[132:135], v16 offset:32768
    ds_read_b64_tr_b16 v[120:121], v20 offset:24576
    v_mfma_f32_32x32x16_bf16 v[208:223], v[144:147], v[156:159], v[208:223]
    ds_read_b64_tr_b16 v[122:123], v20 offset:25344
    ds_read_b128 v[136:139], v16 offset:36864
    v_mfma_f32_32x32x16_bf16 v[224:239], v[148:151], v[152:155], v[224:239]
    ds_read_b64_tr_b16 v[124:125], v22 offset:24576
    ds_read_b64_tr_b16 v[126:127], v22 offset:25344
    v_mfma_f32_32x32x16_bf16 v[240:255], v[148:151], v[156:159], v[240:255]
    ds_read_b64_tr_b16 v[128:129], v21 offset:24576
    ds_read_b64_tr_b16 v[130:131], v21 offset:25344
    s_waitcnt lgkmcnt(5)
    v_mfma_f32_32x32x16_bf16 v[160:175], v[120:123], v[132:135], v[160:175]
    ds_read_b128 v[152:155], v17 offset:32768
    ds_read_b64_tr_b16 v[140:141], v20 offset:27648
    s_waitcnt lgkmcnt(6)
    v_mfma_f32_32x32x16_bf16 v[176:191], v[120:123], v[136:139], v[176:191]
    ds_read_b64_tr_b16 v[142:143], v20 offset:28416
    s_waitcnt lgkmcnt(5)
    v_mfma_f32_32x32x16_bf16 v[192:207], v[124:127], v[132:135], v[192:207]
    ds_read_b128 v[156:159], v17 offset:36864
    ds_read_b64_tr_b16 v[144:145], v22 offset:27648
    v_mfma_f32_32x32x16_bf16 v[208:223], v[124:127], v[136:139], v[208:223]
    ds_read_b64_tr_b16 v[146:147], v22 offset:28416
    s_waitcnt lgkmcnt(6)
    v_mfma_f32_32x32x16_bf16 v[224:239], v[128:131], v[132:135], v[224:239]
    ds_read_b64_tr_b16 v[148:149], v21 offset:27648
    v_mfma_f32_32x32x16_bf16 v[240:255], v[128:131], v[136:139], v[240:255]
    ds_read_b64_tr_b16 v[150:151], v21 offset:28416
    s_waitcnt lgkmcnt(5)
    v_mfma_f32_32x32x16_bf16 v[160:175], v[140:143], v[152:155], v[160:175]
    ds_read_b128 v[132:135], v18 offset:32768
    ds_read_b64_tr_b16 v[120:121], v20 offset:30720
    s_waitcnt lgkmcnt(6)
    v_mfma_f32_32x32x16_bf16 v[176:191], v[140:143], v[156:159], v[176:191]
    ds_read_b64_tr_b16 v[122:123], v20 offset:31488
    s_waitcnt lgkmcnt(5)
    v_mfma_f32_32x32x16_bf16 v[192:207], v[144:147], v[152:155], v[192:207]
    ds_read_b128 v[136:139], v18 offset:36864
    ds_read_b64_tr_b16 v[124:125], v22 offset:30720
    v_mfma_f32_32x32x16_bf16 v[208:223], v[144:147], v[156:159], v[208:223]
    ds_read_b64_tr_b16 v[126:127], v22 offset:31488
    s_waitcnt lgkmcnt(6)
    v_mfma_f32_32x32x16_bf16 v[224:239], v[148:151], v[152:155], v[224:239]
    ds_read_b64_tr_b16 v[128:129], v21 offset:30720
    v_mfma_f32_32x32x16_bf16 v[240:255], v[148:151], v[156:159], v[240:255]
    ds_read_b64_tr_b16 v[130:131], v21 offset:31488
    s_waitcnt lgkmcnt(5)
    v_mfma_f32_32x32x16_bf16 v[160:175], v[120:123], v[132:135], v[160:175]
    ds_read_b128 v[152:155], v19 offset:32768
    ds_read_b64_tr_b16 v[140:141], v20 offset:33792
    s_waitcnt lgkmcnt(6)
    v_mfma_f32_32x32x16_bf16 v[176:191], v[120:123], v[136:139], v[176:191]
    ds_read_b64_tr_b16 v[142:143], v20 offset:34560
    s_waitcnt lgkmcnt(5)
    v_mfma_f32_32x32x16_bf16 v[192:207], v[124:127], v[132:135], v[192:207]
    ds_read_b128 v[156:159], v19 offset:36864
    ds_read_b64_tr_b16 v[144:145], v22 offset:33792
    v_mfma_f32_32x32x16_bf16 v[208:223], v[124:127], v[136:139], v[208:223]
    ds_read_b64_tr_b16 v[146:147], v22 offset:34560
    s_waitcnt lgkmcnt(6)
    v_mfma_f32_32x32x16_bf16 v[224:239], v[128:131], v[132:135], v[224:239]
    ds_read_b64_tr_b16 v[148:149], v21 offset:33792
    v_mfma_f32_32x32x16_bf16 v[240:255], v[128:131], v[136:139], v[240:255]
    ds_read_b64_tr_b16 v[150:151], v21 offset:34560
    s_waitcnt lgkmcnt(5)
    v_mfma_f32_32x32x16_bf16 v[160:175], v[140:143], v[152:155], v[160:175]
    s_waitcnt lgkmcnt(4)
    v_mfma_f32_32x32x16_bf16 v[176:191], v[140:143], v[156:159], v[176:191]
    s_waitcnt lgkmcnt(2)
    v_mfma_f32_32x32x16_bf16 v[192:207], v[144:147], v[152:155], v[192:207]
    s_waitcnt lgkmcnt(0)
    s_barrier
    ds_read_b128 v[132:135], v16 offset:0
    ds_read_b64_tr_b16 v[120:121], v20 offset:0
    v_mfma_f32_32x32x16_bf16 v[208:223], v[144:147], v[156:159], v[208:223]
    ds_read_b64_tr_b16 v[122:123], v20 offset:768
    ds_read_b128 v[136:139], v16 offset:4096
    v_mfma_f32_32x32x16_bf16 v[224:239], v[148:151], v[152:155], v[224:239]
    ds_read_b64_tr_b16 v[124:125], v22 offset:0
    ds_read_b64_tr_b16 v[126:127], v22 offset:768
    v_mfma_f32_32x32x16_bf16 v[240:255], v[148:151], v[156:159], v[240:255]
    ds_read_b64_tr_b16 v[128:129], v21 offset:0
    ds_read_b64_tr_b16 v[130:131], v21 offset:768
    s_waitcnt lgkmcnt(5)
    v_mfma_f32_32x32x16_bf16 v[160:175], v[120:123], v[132:135], v[160:175]
    ds_read_b128 v[152:155], v17 offset:0
    ds_read_b64_tr_b16 v[140:141], v20 offset:3072
    s_waitcnt lgkmcnt(6)
    v_mfma_f32_32x32x16_bf16 v[176:191], v[120:123], v[136:139], v[176:191]
    ds_read_b64_tr_b16 v[142:143], v20 offset:3840
    s_waitcnt lgkmcnt(5)
    v_mfma_f32_32x32x16_bf16 v[192:207], v[124:127], v[132:135], v[192:207]
    ds_read_b128 v[156:159], v17 offset:4096
    ds_read_b64_tr_b16 v[144:145], v22 offset:3072
    v_mfma_f32_32x32x16_bf16 v[208:223], v[124:127], v[136:139], v[208:223]
    ds_read_b64_tr_b16 v[146:147], v22 offset:3840
    s_waitcnt lgkmcnt(6)
    v_mfma_f32_32x32x16_bf16 v[224:239], v[128:131], v[132:135], v[224:239]
    ds_read_b64_tr_b16 v[148:149], v21 offset:3072
    v_mfma_f32_32x32x16_bf16 v[240:255], v[128:131], v[136:139], v[240:255]
    ds_read_b64_tr_b16 v[150:151], v21 offset:3840
    s_waitcnt lgkmcnt(5)
    v_mfma_f32_32x32x16_bf16 v[160:175], v[140:143], v[152:155], v[160:175]
    ds_read_b128 v[132:135], v18 offset:0
    ds_read_b64_tr_b16 v[120:121], v20 offset:6144
    s_waitcnt lgkmcnt(6)
    v_mfma_f32_32x32x16_bf16 v[176:191], v[140:143], v[156:159], v[176:191]
    ds_read_b64_tr_b16 v[122:123], v20 offset:6912
    s_waitcnt lgkmcnt(5)
    v_mfma_f32_32x32x16_bf16 v[192:207], v[144:147], v[152:155], v[192:207]
    ds_read_b128 v[136:139], v18 offset:4096
    ds_read_b64_tr_b16 v[124:125], v22 offset:6144
    v_mfma_f32_32x32x16_bf16 v[208:223], v[144:147], v[156:159], v[208:223]
    ds_read_b64_tr_b16 v[126:127], v22 offset:6912
    s_waitcnt lgkmcnt(6)
    v_mfma_f32_32x32x16_bf16 v[224:239], v[148:151], v[152:155], v[224:239]
    ds_read_b64_tr_b16 v[128:129], v21 offset:6144
    v_mfma_f32_32x32x16_bf16 v[240:255], v[148:151], v[156:159], v[240:255]
    ds_read_b64_tr_b16 v[130:131], v21 offset:6912
    s_waitcnt lgkmcnt(5)
    v_mfma_f32_32x32x16_bf16 v[160:175], v[120:123], v[132:135], v[160:175]
    ds_read_b128 v[152:155], v19 offset:0
    ds_read_b64_tr_b16 v[140:141], v20 offset:9216
    s_waitcnt lgkmcnt(6)
    v_mfma_f32_32x32x16_bf16 v[176:191], v[120:123], v[136:139], v[176:191]
    ds_read_b64_tr_b16 v[142:143], v20 offset:9984
    s_waitcnt lgkmcnt(5)
    v_mfma_f32_32x32x16_bf16 v[192:207], v[124:127], v[132:135], v[192:207]
    ds_read_b128 v[156:159], v19 offset:4096
    ds_read_b64_tr_b16 v[144:145], v22 offset:9216
    v_mfma_f32_32x32x16_bf16 v[208:223], v[124:127], v[136:139], v[208:223]
    ds_read_b64_tr_b16 v[146:147], v22 offset:9984
    s_waitcnt lgkmcnt(6)
    v_mfma_f32_32x32x16_bf16 v[224:239], v[128:131], v[132:135], v[224:239]
    ds_read_b64_tr_b16 v[148:149], v21 offset:9216
    v_mfma_f32_32x32x16_bf16 v[240:255], v[128:131], v[136:139], v[240:255]
    ds_read_b64_tr_b16 v[150:151], v21 offset:9984
    s_waitcnt lgkmcnt(5)
    v_mfma_f32_32x32x16_bf16 v[160:175], v[140:143], v[152:155], v[160:175]
    s_waitcnt lgkmcnt(4)
    v_mfma_f32_32x32x16_bf16 v[176:191], v[140:143], v[156:159], v[176:191]
    s_waitcnt lgkmcnt(2)
    v_mfma_f32_32x32x16_bf16 v[192:207], v[144:147], v[152:155], v[192:207]
    s_waitcnt lgkmcnt(0)
    s_barrier
    s_setprio 2
    ds_read_b128 v[132:135], v16 offset:16384
    ds_read_b64_tr_b16 v[120:121], v20 offset:12288
    v_mfma_f32_32x32x16_bf16 v[208:223], v[144:147], v[156:159], v[208:223]
    ds_read_b64_tr_b16 v[122:123], v20 offset:13056
    ds_read_b128 v[136:139], v16 offset:20480
    v_mfma_f32_32x32x16_bf16 v[224:239], v[148:151], v[152:155], v[224:239]
    ds_read_b64_tr_b16 v[124:125], v22 offset:12288
    ds_read_b64_tr_b16 v[126:127], v22 offset:13056
    v_mfma_f32_32x32x16_bf16 v[240:255], v[148:151], v[156:159], v[240:255]
    ds_read_b64_tr_b16 v[128:129], v21 offset:12288
    ds_read_b64_tr_b16 v[130:131], v21 offset:13056
    s_waitcnt lgkmcnt(5)
    v_mfma_f32_32x32x16_bf16 v[160:175], v[120:123], v[132:135], v[160:175]
    ds_read_b128 v[152:155], v17 offset:16384
    ds_read_b64_tr_b16 v[140:141], v20 offset:15360
    s_waitcnt lgkmcnt(6)
    v_mfma_f32_32x32x16_bf16 v[176:191], v[120:123], v[136:139], v[176:191]
    ds_read_b64_tr_b16 v[142:143], v20 offset:16128
    s_waitcnt lgkmcnt(5)
    v_mfma_f32_32x32x16_bf16 v[192:207], v[124:127], v[132:135], v[192:207]
    ds_read_b128 v[156:159], v17 offset:20480
    ds_read_b64_tr_b16 v[144:145], v22 offset:15360
    v_mfma_f32_32x32x16_bf16 v[208:223], v[124:127], v[136:139], v[208:223]
    ds_read_b64_tr_b16 v[146:147], v22 offset:16128
    s_waitcnt lgkmcnt(6)
    v_mfma_f32_32x32x16_bf16 v[224:239], v[128:131], v[132:135], v[224:239]
    ds_read_b64_tr_b16 v[148:149], v21 offset:15360
    v_mfma_f32_32x32x16_bf16 v[240:255], v[128:131], v[136:139], v[240:255]
    ds_read_b64_tr_b16 v[150:151], v21 offset:16128
    s_waitcnt lgkmcnt(5)
    v_mfma_f32_32x32x16_bf16 v[160:175], v[140:143], v[152:155], v[160:175]
    ds_read_b128 v[132:135], v18 offset:16384
    ds_read_b64_tr_b16 v[120:121], v20 offset:18432
    s_waitcnt lgkmcnt(6)
    v_mfma_f32_32x32x16_bf16 v[176:191], v[140:143], v[156:159], v[176:191]
    ds_read_b64_tr_b16 v[122:123], v20 offset:19200
    s_waitcnt lgkmcnt(5)
    v_mfma_f32_32x32x16_bf16 v[192:207], v[144:147], v[152:155], v[192:207]
    ds_read_b128 v[136:139], v18 offset:20480
    ds_read_b64_tr_b16 v[124:125], v22 offset:18432
    v_mfma_f32_32x32x16_bf16 v[208:223], v[144:147], v[156:159], v[208:223]
    ds_read_b64_tr_b16 v[126:127], v22 offset:19200
    s_waitcnt lgkmcnt(6)
    v_mfma_f32_32x32x16_bf16 v[224:239], v[148:151], v[152:155], v[224:239]
    ds_read_b64_tr_b16 v[128:129], v21 offset:18432
    v_mfma_f32_32x32x16_bf16 v[240:255], v[148:151], v[156:159], v[240:255]
    ds_read_b64_tr_b16 v[130:131], v21 offset:19200
    s_waitcnt lgkmcnt(5)
    v_mfma_f32_32x32x16_bf16 v[160:175], v[120:123], v[132:135], v[160:175]
    ds_read_b128 v[152:155], v19 offset:16384
    ds_read_b64_tr_b16 v[140:141], v20 offset:21504
    s_waitcnt lgkmcnt(6)
    v_mfma_f32_32x32x16_bf16 v[176:191], v[120:123], v[136:139], v[176:191]
    ds_read_b64_tr_b16 v[142:143], v20 offset:22272
    s_waitcnt lgkmcnt(5)
    v_mfma_f32_32x32x16_bf16 v[192:207], v[124:127], v[132:135], v[192:207]
    ds_read_b128 v[156:159], v19 offset:20480
    ds_read_b64_tr_b16 v[144:145], v22 offset:21504
    v_mfma_f32_32x32x16_bf16 v[208:223], v[124:127], v[136:139], v[208:223]
    ds_read_b64_tr_b16 v[146:147], v22 offset:22272
    s_waitcnt lgkmcnt(6)
    v_mfma_f32_32x32x16_bf16 v[224:239], v[128:131], v[132:135], v[224:239]
    ds_read_b64_tr_b16 v[148:149], v21 offset:21504
    v_mfma_f32_32x32x16_bf16 v[240:255], v[128:131], v[136:139], v[240:255]
    ds_read_b64_tr_b16 v[150:151], v21 offset:22272
    s_waitcnt lgkmcnt(5)
    v_mfma_f32_32x32x16_bf16 v[160:175], v[140:143], v[152:155], v[160:175]
    ds_read_b32 v1, v29 offset:52
    s_waitcnt lgkmcnt(5)
    v_mfma_f32_32x32x16_bf16 v[176:191], v[140:143], v[156:159], v[176:191]
    s_waitcnt lgkmcnt(3)
    v_mfma_f32_32x32x16_bf16 v[192:207], v[144:147], v[152:155], v[192:207]
    s_waitcnt lgkmcnt(0)
    v_readfirstlane_b32 s78, v1
    s_cmp_ge_u32 s78, 4
    s_cbranch_scc1 POK_3
    s_mov_b32 s79, 524288
SPIN_4:
    ds_read_b32 v1, v29 offset:52
    s_waitcnt lgkmcnt(0)
    v_readfirstlane_b32 s78, v1
    s_cmp_ge_u32 s78, 4
    s_cbranch_scc1 SPINX_5
    s_sub_u32 s79, s79, 1
    s_cmp_lg_u32 s79, 0
    s_cbranch_scc1 SPIN_4
SPINX_5:
POK_3:
    ds_read2_b32 v[132:133], v31 offset0:0 offset1:0
    ds_read2_b32 v[134:135], v31 offset0:0 offset1:0
    ds_read_b64_tr_b16 v[120:121], v20 offset:24576
    v_mfma_f32_32x32x16_bf16 v[208:223], v[144:147], v[156:159], v[208:223]
    ds_read_b64_tr_b16 v[122:123], v20 offset:25344
    ds_read_b64_tr_b16 v[128:129], v21 offset:24576
    v_mfma_f32_32x32x16_bf16 v[224:239], v[148:151], v[152:155], v[224:239]
    ds_read_b64_tr_b16 v[130:131], v21 offset:25344
    ds_read_b64_tr_b16 v[124:125], v22 offset:24576
    v_mfma_f32_32x32x16_bf16 v[240:255], v[148:151], v[156:159], v[240:255]
    ds_read_b64_tr_b16 v[126:127], v22 offset:25344
    ds_read2_b32 v[136:137], v31 offset0:64 offset1:64
    ds_read2_b32 v[138:139], v31 offset0:64 offset1:64
    s_waitcnt lgkmcnt(6)
    v_mfma_f32_32x32x16_bf16 v[160:175], v[120:123], v[132:135], v[160:175]
    s_waitcnt lgkmcnt(4)
    v_mfma_f32_32x32x16_bf16 v[224:239], v[128:131], v[132:135], v[224:239]
    s_waitcnt lgkmcnt(2)
    v_mfma_f32_32x32x16_bf16 v[192:207], v[124:127], v[132:135], v[192:207]
    s_waitcnt lgkmcnt(0)
    v_mfma_f32_32x32x16_bf16 v[176:191], v[120:123], v[136:139], v[176:191]
    v_mfma_f32_32x32x16_bf16 v[240:255], v[128:131], v[136:139], v[240:255]
    v_mfma_f32_32x32x16_bf16 v[208:223], v[124:127], v[136:139], v[208:223]
    s_mov_b64 exec, 1
    ds_add_u32 v29, v7 offset:56
    s_mov_b64 exec, -1
    s_nop 2
    v_pk_mul_f32 v[160:161], v[160:161], v[224:225]
    v_pk_mul_f32 v[162:163], v[162:163], v[226:227]
    v_pk_mul_f32 v[164:165], v[164:165], v[228:229]
    v_pk_mul_f32 v[166:167], v[166:167], v[230:231]
    v_cvt_pk_bf16_f32 v160, v160, v161
    v_cvt_pk_bf16_f32 v161, v162, v163
    v_cvt_pk_bf16_f32 v162, v164, v165
    v_cvt_pk_bf16_f32 v163, v166, v167
    buffer_store_dwordx4 v[160:163], v25, s[56:59], s70 offen offset:0 sc1
    v_pk_mul_f32 v[168:169], v[168:169], v[232:233]
    v_pk_mul_f32 v[170:171], v[170:171], v[234:235]
    v_pk_mul_f32 v[172:173], v[172:173], v[236:237]
    v_pk_mul_f32 v[174:175], v[174:175], v[238:239]
    v_cvt_pk_bf16_f32 v168, v168, v169
    v_cvt_pk_bf16_f32 v169, v170, v171
    v_cvt_pk_bf16_f32 v170, v172, v173
    v_cvt_pk_bf16_f32 v171, v174, v175
    buffer_store_dwordx4 v[168:171], v25, s[56:59], s70 offen offset:1024 sc1
    v_pk_mul_f32 v[192:193], v[192:193], v[200:201]
    v_pk_mul_f32 v[194:195], v[194:195], v[202:203]
    v_pk_mul_f32 v[196:197], v[196:197], v[204:205]
    v_pk_mul_f32 v[198:199], v[198:199], v[206:207]
    v_cvt_pk_bf16_f32 v192, v192, v193
    v_cvt_pk_bf16_f32 v193, v194, v195
    v_cvt_pk_bf16_f32 v194, v196, v197
    v_cvt_pk_bf16_f32 v195, v198, v199
    buffer_store_dwordx4 v[192:195], v26, s[56:59], s70 offen offset:2048 sc1
    v_pk_mul_f32 v[176:177], v[176:177], v[240:241]
    v_pk_mul_f32 v[178:179], v[178:179], v[242:243]
    v_pk_mul_f32 v[180:181], v[180:181], v[244:245]
    v_pk_mul_f32 v[182:183], v[182:183], v[246:247]
    v_cvt_pk_bf16_f32 v176, v176, v177
    v_cvt_pk_bf16_f32 v177, v178, v179
    v_cvt_pk_bf16_f32 v178, v180, v181
    v_cvt_pk_bf16_f32 v179, v182, v183
    buffer_store_dwordx4 v[176:179], v25, s[56:59], s71 offen offset:0 sc1
    v_pk_mul_f32 v[184:185], v[184:185], v[248:249]
    v_pk_mul_f32 v[186:187], v[186:187], v[250:251]
    v_pk_mul_f32 v[188:189], v[188:189], v[252:253]
    v_pk_mul_f32 v[190:191], v[190:191], v[254:255]
    v_cvt_pk_bf16_f32 v184, v184, v185
    v_cvt_pk_bf16_f32 v185, v186, v187
    v_cvt_pk_bf16_f32 v186, v188, v189
    v_cvt_pk_bf16_f32 v187, v190, v191
    buffer_store_dwordx4 v[184:187], v25, s[56:59], s71 offen offset:1024 sc1
    v_pk_mul_f32 v[208:209], v[208:209], v[216:217]
    v_pk_mul_f32 v[210:211], v[210:211], v[218:219]
    v_pk_mul_f32 v[212:213], v[212:213], v[220:221]
    v_pk_mul_f32 v[214:215], v[214:215], v[222:223]
    v_cvt_pk_bf16_f32 v208, v208, v209
    v_cvt_pk_bf16_f32 v209, v210, v211
    v_cvt_pk_bf16_f32 v210, v212, v213
    v_cvt_pk_bf16_f32 v211, v214, v215
    buffer_store_dwordx4 v[208:211], v26, s[56:59], s71 offen offset:2048 sc1
    s_mov_b32 s79, 524288
SPIN_6:
    ds_read_b32 v1, v29 offset:56
    s_waitcnt lgkmcnt(0)
    v_readfirstlane_b32 s78, v1
    s_cmp_ge_u32 s78, 4
    s_cbranch_scc1 SPINX_7
    s_sub_u32 s79, s79, 1
    s_cmp_lg_u32 s79, 0
    s_cbranch_scc1 SPIN_6
SPINX_7:
    s_add_u32 m0, s36, 51200
    s_nop 0
    buffer_load_dwordx4 v30, s[48:51], s39 offen lds
    s_add_u32 s39, s39, 16384
    s_cmp_eq_u32 s39, s41
    s_cselect_b32 s39, s40, s39
    s_add_u32 m0, s36, 52224
    s_nop 0
    buffer_load_dwordx4 v30, s[48:51], s39 offen lds
    s_add_u32 s39, s39, 16384
    s_cmp_eq_u32 s39, s41
    s_cselect_b32 s39, s40, s39
    s_add_u32 m0, s36, 53248
    s_nop 0
    buffer_load_dwordx4 v30, s[48:51], s39 offen lds
    s_add_u32 s39, s39, 16384
    s_cmp_eq_u32 s39, s41
    s_cselect_b32 s39, s40, s39
    s_add_u32 m0, s36, 54272
    s_nop 0
    buffer_load_dwordx4 v30, s[48:51], s39 offen lds
    s_add_u32 s39, s39, 16384
    s_cmp_eq_u32 s39, s41
    s_cselect_b32 s39, s40, s39
    s_add_u32 m0, s37, 96256
    s_nop 0
    buffer_load_dwordx4 v30, s[48:51], s39 offen lds
    s_add_u32 s39, s39, 16384
    s_cmp_eq_u32 s39, s41
    s_cselect_b32 s39, s40, s39
    s_add_u32 m0, s37, 97280
    s_nop 0
    buffer_load_dwordx4 v30, s[48:51], s39 offen lds
    s_add_u32 s39, s39, 16384
    s_cmp_eq_u32 s39, s41
    s_cselect_b32 s39, s40, s39
    s_add_u32 m0, s37, 98304
    s_nop 0
    buffer_load_dwordx4 v30, s[48:51], s39 offen lds
    s_add_u32 s39, s39, 16384
    s_cmp_eq_u32 s39, s41
    s_cselect_b32 s39, s40, s39
    s_add_u32 m0, s37, 133152
    s_nop 0
    buffer_load_dwordx4 v30, s[48:51], s39 offen lds
    s_add_u32 s39, s39, 16384
    s_cmp_eq_u32 s39, s41
    s_cselect_b32 s39, s40, s39
    s_add_u32 m0, s37, 134176
    s_nop 0
    buffer_load_dwordx4 v30, s[48:51], s39 offen lds
    s_add_u32 s39, s39, 16384
    s_cmp_eq_u32 s39, s41
    s_cselect_b32 s39, s40, s39
    s_add_u32 m0, s37, 135200
    s_nop 0
    buffer_load_dwordx4 v30, s[48:51], s39 offen lds
    s_add_u32 s39, s39, 16384
    s_cmp_eq_u32 s39, s41
    s_cselect_b32 s39, s40, s39
    s_add_u32 m0, s38, 145440
    s_nop 0
    buffer_load_dwordx4 v30, s[48:51], s39 offen lds
    s_add_u32 s39, s39, 16384
    s_cmp_eq_u32 s39, s41
    s_cselect_b32 s39, s40, s39
    v_lshrrev_b32 v1, 2, v0
    v_mul_u32_u24 v1, 14, v1
    v_sub_u32 v1, s11, v1
    v_cmp_gt_u32 vcc, 16, v1
    v_lshlrev_b32 v2, 7, v0
    v_lshl_add_u32 v2, v1, 2, v2
    v_mov_b32 v1, s60
    s_and_b32 vcc_lo, vcc_lo, 255
    s_mov_b32 vcc_hi, 0
    s_waitcnt vmcnt(11)
    s_mov_b64 exec, vcc
    buffer_store_dword v1, v2, s[56:59], s9 offen sc1
    s_mov_b64 exec, -1
    v_lshrrev_b32 v1, 10, v15
    v_lshlrev_b32 v1, 3, v1
    s_movk_i32 s66, 4100
    buffer_load_dword v160, v1, s[56:59], s66 offen sc1
    s_mov_b32 s79, 524288
SPIN_8:
    ds_read_b32 v1, v28 offset:0
    s_waitcnt lgkmcnt(0)
    v_readfirstlane_b32 s78, v1
    s_cmp_ge_u32 s78, 2
    s_cbranch_scc1 SPINX_9
    s_sub_u32 s79, s79, 1
    s_cmp_lg_u32 s79, 0
    s_cbranch_scc1 SPIN_8
SPINX_9:
    ds_read_b64_tr_b16 v[32:33], v8 offset:32768
    ds_read_b64_tr_b16 v[34:35], v8 offset:36864
    ds_read_b64_tr_b16 v[36:37], v9 offset:32768
    ds_read_b64_tr_b16 v[38:39], v9 offset:36864
    ds_read_b64_tr_b16 v[40:41], v8 offset:33792
    ds_read_b64_tr_b16 v[42:43], v8 offset:37888
    ds_read_b64_tr_b16 v[44:45], v9 offset:33792
    ds_read_b64_tr_b16 v[46:47], v9 offset:37888
    ds_read_b64_tr_b16 v[48:49], v8 offset:34816
    ds_read_b64_tr_b16 v[50:51], v8 offset:38912
    ds_read_b64_tr_b16 v[52:53], v9 offset:34816
    ds_read_b64_tr_b16 v[54:55], v9 offset:38912
    ds_read_b64_tr_b16 v[56:57], v8 offset:35840
    ds_read_b64_tr_b16 v[58:59], v8 offset:39936
    ds_read_b64_tr_b16 v[60:61], v9 offset:35840
    ds_read_b64_tr_b16 v[62:63], v9 offset:39936
    ds_read_b64_tr_b16 v[64:65], v12 offset:4096
    ds_read_b64_tr_b16 v[66:67], v12 offset:5120
    ds_read_b64_tr_b16 v[68:69], v13 offset:4096
    ds_read_b64_tr_b16 v[70:71], v13 offset:5120
    ds_read_b64_tr_b16 v[72:73], v12 offset:8192
    ds_read_b64_tr_b16 v[74:75], v12 offset:9216
    ds_read_b64_tr_b16 v[76:77], v13 offset:8192
    ds_read_b64_tr_b16 v[78:79], v13 offset:9216
    ds_read_b64_tr_b16 v[80:81], v8 offset:0
    ds_read_b64_tr_b16 v[82:83], v8 offset:4096
    ds_read_b64_tr_b16 v[84:85], v9 offset:0
    ds_read_b64_tr_b16 v[86:87], v9 offset:4096
    ds_read_b64_tr_b16 v[88:89], v8 offset:1024
    ds_read_b64_tr_b16 v[90:91], v8 offset:5120
    ds_read_b64_tr_b16 v[92:93], v9 offset:1024
    ds_read_b64_tr_b16 v[94:95], v9 offset:5120
    ds_read_b64_tr_b16 v[96:97], v8 offset:2048
    ds_read_b64_tr_b16 v[98:99], v8 offset:6144
    ds_read_b64_tr_b16 v[100:101], v9 offset:2048
    ds_read_b64_tr_b16 v[102:103], v9 offset:6144
    ds_read_b64_tr_b16 v[104:105], v8 offset:3072
    ds_read_b64_tr_b16 v[106:107], v8 offset:7168
    ds_read_b64_tr_b16 v[108:109], v9 offset:3072
    ds_read_b64_tr_b16 v[110:111], v9 offset:7168
    ds_read_b64_tr_b16 v[112:113], v10 offset:0
    ds_read_b64_tr_b16 v[114:115], v10 offset:3072
    ds_read_b64_tr_b16 v[116:117], v11 offset:0
    ds_read_b64_tr_b16 v[118:119], v11 offset:3072
    ds_read_b64_tr_b16 v[120:121], v10 offset:1024
    ds_read_b64_tr_b16 v[122:123], v10 offset:4096
    ds_read_b64_tr_b16 v[124:125], v11 offset:1024
    ds_read_b64_tr_b16 v[126:127], v11 offset:4096
    ds_read_b64_tr_b16 v[128:129], v10 offset:2048
    ds_read_b64_tr_b16 v[130:131], v10 offset:5120
    ds_read_b64_tr_b16 v[132:133], v11 offset:2048
    ds_read_b64_tr_b16 v[134:135], v11 offset:5120
    ds_read_b64_tr_b16 v[136:137], v10 offset:36896
    ds_read_b64_tr_b16 v[138:139], v10 offset:39968
    ds_read_b64_tr_b16 v[140:141], v11 offset:36896
    ds_read_b64_tr_b16 v[142:143], v11 offset:39968
    ds_read_b64_tr_b16 v[144:145], v10 offset:37920
    ds_read_b64_tr_b16 v[146:147], v10 offset:40992
    ds_read_b64_tr_b16 v[148:149], v11 offset:37920
    ds_read_b64_tr_b16 v[150:151], v11 offset:40992
    ds_read_b64_tr_b16 v[152:153], v10 offset:38944
    ds_read_b64_tr_b16 v[154:155], v10 offset:42016
    ds_read_b64_tr_b16 v[156:157], v11 offset:38944
    ds_read_b64_tr_b16 v[158:159], v11 offset:42016
    s_mov_b64 exec, 1
    ds_add_u32 v28, v7 offset:8
    s_mov_b64 exec, -1
    s_mov_b32 s79, 524288
SPIN_10:
    ds_read_b32 v1, v28 offset:8
    s_waitcnt lgkmcnt(0)
    v_readfirstlane_b32 s78, v1
    s_cmp_ge_u32 s78, 2
    s_cbranch_scc1 SPINX_11
    s_sub_u32 s79, s79, 1
    s_cmp_lg_u32 s79, 0
    s_cbranch_scc1 SPIN_10
SPINX_11:
    s_add_u32 m0, s36, 67584
    s_nop 0
    buffer_load_dwordx4 v30, s[48:51], s39 offen lds
    s_add_u32 s39, s39, 16384
    s_cmp_eq_u32 s39, s41
    s_cselect_b32 s39, s40, s39
    s_add_u32 m0, s36, 68608
    s_nop 0
    buffer_load_dwordx4 v30, s[48:51], s39 offen lds
    s_add_u32 s39, s39, 16384
    s_cmp_eq_u32 s39, s41
    s_cselect_b32 s39, s40, s39
    s_add_u32 m0, s36, 69632
    s_nop 0
    buffer_load_dwordx4 v30, s[48:51], s39 offen lds
    s_add_u32 s39, s39, 16384
    s_cmp_eq_u32 s39, s41
    s_cselect_b32 s39, s40, s39
    s_add_u32 m0, s36, 70656
    s_nop 0
    buffer_load_dwordx4 v30, s[48:51], s39 offen lds
    s_add_u32 s39, s39, 16384
    s_cmp_eq_u32 s39, s41
    s_cselect_b32 s39, s40, s39
    s_add_u32 m0, s38, 149536
    s_nop 0
    buffer_load_dwordx4 v30, s[48:51], s39 offen lds
    s_add_u32 s39, s39, 16384
    s_cmp_eq_u32 s39, s41
    s_cselect_b32 s39, s40, s39
    s_add_u32 m0, s38, 153632
    s_nop 0
    buffer_load_dwordx4 v30, s[48:51], s39 offen lds
    s_add_u32 s39, s39, 16384
    s_cmp_eq_u32 s39, s41
    s_cselect_b32 s39, s40, s39
    s_add_u32 m0, s36, 34816
    s_nop 0
    buffer_load_dwordx4 v30, s[48:51], s39 offen lds
    s_add_u32 s39, s39, 16384
    s_cmp_eq_u32 s39, s41
    s_cselect_b32 s39, s40, s39
    s_add_u32 m0, s36, 35840
    s_nop 0
    buffer_load_dwordx4 v30, s[48:51], s39 offen lds
    s_add_u32 s39, s39, 16384
    s_cmp_eq_u32 s39, s41
    s_cselect_b32 s39, s40, s39
    s_add_u32 m0, s36, 36864
    s_nop 0
    buffer_load_dwordx4 v30, s[48:51], s39 offen lds
    s_add_u32 s39, s39, 16384
    s_cmp_eq_u32 s39, s41
    s_cselect_b32 s39, s40, s39
    s_add_u32 m0, s36, 37888
    s_nop 0
    buffer_load_dwordx4 v30, s[48:51], s39 offen lds
    s_add_u32 s39, s39, 16384
    s_cmp_eq_u32 s39, s41
    s_cselect_b32 s39, s40, s39
    s_load_dwordx16 s[16:31], s[34:35], s10 glc
    s_add_u32 m0, s37, 83968
    s_nop 0
    buffer_load_dwordx4 v30, s[48:51], s39 offen lds
    s_add_u32 s39, s39, 16384
    s_cmp_eq_u32 s39, s41
    s_cselect_b32 s39, s40, s39
    s_add_u32 m0, s37, 84992
    s_nop 0
    buffer_load_dwordx4 v30, s[48:51], s39 offen lds
    s_add_u32 s39, s39, 16384
    s_cmp_eq_u32 s39, s41
    s_cselect_b32 s39, s40, s39
    s_add_u32 m0, s37, 86016
    s_nop 0
    buffer_load_dwordx4 v30, s[48:51], s39 offen lds
    s_add_u32 s39, s39, 16384
    s_cmp_eq_u32 s39, s41
    s_cselect_b32 s39, s40, s39
    s_add_u32 m0, s37, 120864
    s_nop 0
    buffer_load_dwordx4 v30, s[48:51], s39 offen lds
    s_add_u32 s39, s39, 16384
    s_cmp_eq_u32 s39, s41
    s_cselect_b32 s39, s40, s39
    s_add_u32 m0, s37, 121888
    s_nop 0
    buffer_load_dwordx4 v30, s[48:51], s39 offen lds
    s_add_u32 s39, s39, 16384
    s_cmp_eq_u32 s39, s41
    s_cselect_b32 s39, s40, s39
    s_add_u32 m0, s37, 122912
    s_nop 0
    buffer_load_dwordx4 v30, s[48:51], s39 offen lds
    s_mov_b32 s79, 65536
    s_branch SPI_15
SP_12:
    s_load_dwordx16 s[16:31], s[34:35], s10 glc
SPI_15:
    s_waitcnt lgkmcnt(0)
    s_cmp_eq_u64 s[16:17], s[60:61]
    s_cbranch_scc0 SPR_13
    s_cmp_eq_u64 s[18:19], s[60:61]
    s_cbranch_scc0 SPR_13
    s_cmp_eq_u64 s[20:21], s[60:61]
    s_cbranch_scc0 SPR_13
    s_cmp_eq_u64 s[22:23], s[60:61]
    s_cbranch_scc0 SPR_13
    s_cmp_eq_u64 s[24:25], s[60:61]
    s_cbranch_scc0 SPR_13
    s_cmp_eq_u64 s[26:27], s[60:61]
    s_cbranch_scc0 SPR_13
    s_cmp_eq_u64 s[28:29], s[60:61]
    s_cbranch_scc0 SPR_13
    s_cmp_eq_u64 s[30:31], s[60:61]
    s_cbranch_scc1 SPX_14
SPR_13:
    s_sub_u32 s79, s79, 1
    s_cmp_lg_u32 s79, 0
    s_cbranch_scc1 SP_12
SPX_14:
    buffer_load_dwordx4 v[176:179], v27, s[56:59], s6 offen sc1
    s_add_u32 s6, s6, 1024
    s_cmp_eq_u32 s6, s8
    s_cselect_b32 s6, s7, s6
    buffer_load_dwordx4 v[180:183], v27, s[56:59], s6 offen sc1
    s_add_u32 s6, s6, 1024
    s_cmp_eq_u32 s6, s8
    s_cselect_b32 s6, s7, s6
    buffer_load_dwordx4 v[184:187], v27, s[56:59], s6 offen sc1
    s_add_u32 s6, s6, 1024
    s_cmp_eq_u32 s6, s8
    s_cselect_b32 s6, s7, s6
    buffer_load_dwordx4 v[188:191], v27, s[56:59], s6 offen sc1
    s_add_u32 s6, s6, 1024
    s_cmp_eq_u32 s6, s8
    s_cselect_b32 s6, s7, s6
    buffer_load_dwordx4 v[192:195], v27, s[56:59], s6 offen sc1
    s_add_u32 s6, s6, 1024
    s_cmp_eq_u32 s6, s8
    s_cselect_b32 s6, s7, s6
    buffer_load_dwordx4 v[196:199], v27, s[56:59], s6 offen sc1
    s_add_u32 s6, s6, 1024
    s_cmp_eq_u32 s6, s8
    s_cselect_b32 s6, s7, s6
    buffer_load_dwordx4 v[200:203], v27, s[56:59], s6 offen sc1
    s_add_u32 s6, s6, 1024
    s_cmp_eq_u32 s6, s8
    s_cselect_b32 s6, s7, s6
    buffer_load_dwordx4 v[204:207], v27, s[56:59], s6 offen sc1
    s_add_u32 s6, s6, 1024
    s_cmp_eq_u32 s6, s8
    s_cselect_b32 s6, s7, s6
    buffer_load_dwordx4 v[208:211], v27, s[56:59], s6 offen sc1
    s_add_u32 s6, s6, 1024
    s_cmp_eq_u32 s6, s8
    s_cselect_b32 s6, s7, s6
    buffer_load_dwordx4 v[212:215], v27, s[56:59], s6 offen sc1
    s_add_u32 s6, s6, 1024
    s_cmp_eq_u32 s6, s8
    s_cselect_b32 s6, s7, s6
    s_waitcnt vmcnt(9)
    v_mfma_f32_32x32x16_bf16 v[224:239], v[32:35], v[176:179], 0
    s_mov_b64 exec, 1
    ds_add_u32 v28, v7 offset:16
    s_mov_b64 exec, -1
    v_mfma_f32_32x32x16_bf16 v[240:255], v[36:39], v[176:179], 0
    buffer_load_dwordx4 v[176:179], v27, s[56:59], s6 offen sc1
    s_add_u32 s6, s6, 1024
    s_cmp_eq_u32 s6, s8
    s_cselect_b32 s6, s7, s6
    s_waitcnt vmcnt(9)
    v_mfma_f32_32x32x16_bf16 v[224:239], v[40:43], v[180:183], v[224:239]
    s_mul_i32 s66, s75, 17408
    s_lshl_b32 s67, s74, 11
    s_add_u32 s66, s66, s67
    s_add_u32 s66, s66, 12288
    v_mfma_f32_32x32x16_bf16 v[240:255], v[44:47], v[180:183], v[240:255]
    buffer_load_dwordx4 v[180:183], v27, s[56:59], s6 offen sc1
    s_add_u32 s6, s6, 1024
    s_cmp_eq_u32 s6, s8
    s_cselect_b32 s6, s7, s6
    v_and_b32 v1, 31, v0
    s_waitcnt vmcnt(9)
    v_mfma_f32_32x32x16_bf16 v[224:239], v[48:51], v[184:187], v[224:239]
    v_bfe_u32 v2, v0, 2, 2
    v_mfma_f32_32x32x16_bf16 v[240:255], v[52:55], v[184:187], v[240:255]
    buffer_load_dwordx4 v[184:187], v27, s[56:59], s6 offen sc1
    s_add_u32 s6, s6, 1024
    s_cmp_eq_u32 s6, s8
    s_cselect_b32 s6, s7, s6
    v_lshl_add_u32 v1, v1, 6, s66
    s_waitcnt vmcnt(9)
    v_mfma_f32_32x32x16_bf16 v[224:239], v[56:59], v[188:191], v[224:239]
    v_lshl_add_u32 v1, v2, 4, v1
    v_mfma_f32_32x32x16_bf16 v[240:255], v[60:63], v[188:191], v[240:255]
    buffer_load_dwordx4 v[188:191], v27, s[56:59], s6 offen sc1
    s_add_u32 s6, s6, 1024
    s_cmp_eq_u32 s6, s8
    s_cselect_b32 s6, s7, s6
    v_lshrrev_b32 v2, 5, v0
    s_waitcnt vmcnt(9)
    v_mfma_f32_32x32x16_bf16 v[224:239], v[64:67], v[192:195], v[224:239]
    v_lshl_add_u32 v161, v2, 3, v1
    v_mfma_f32_32x32x16_bf16 v[240:255], v[68:71], v[192:195], v[240:255]
    buffer_load_dwordx4 v[192:195], v27, s[56:59], s6 offen sc1
    s_add_u32 s6, s6, 1024
    s_cmp_eq_u32 s6, s8
    s_cselect_b32 s6, s7, s6
    v_xor_b32 v162, 16, v161
    s_waitcnt vmcnt(9)
    v_mfma_f32_32x32x16_bf16 v[224:239], v[72:75], v[196:199], v[224:239]
    v_xor_b32 v163, 32, v161
    v_mfma_f32_32x32x16_bf16 v[240:255], v[76:79], v[196:199], v[240:255]
    buffer_load_dwordx4 v[196:199], v27, s[56:59], s6 offen sc1
    s_add_u32 s6, s6, 1024
    s_cmp_eq_u32 s6, s8
    s_cselect_b32 s6, s7, s6
    v_xor_b32 v164, 48, v161
    s_waitcnt vmcnt(9)
    v_mfma_f32_32x32x16_bf16 v[224:239], v[80:83], v[200:203], v[224:239]
    s_lshl_b32 s66, s3, 12
    s_add_u32 s66, s66, 51200
    v_add_u32 v5, s66, v27
    v_mfma_f32_32x32x16_bf16 v[240:255], v[84:87], v[200:203], v[240:255]
    buffer_load_dwordx4 v[200:203], v27, s[56:59], s6 offen sc1
    s_add_u32 s6, s6, 1024
    s_cmp_eq_u32 s6, s8
    s_cselect_b32 s6, s7, s6
    s_xor_b32 s66, s3, 2
    s_lshl_b32 s66, s66, 12
    s_add_u32 s66, s66, 51200
    v_add_u32 v6, s66, v27
    s_waitcnt vmcnt(9)
    v_mfma_f32_32x32x16_bf16 v[224:239], v[88:91], v[204:207], v[224:239]
    v_mfma_f32_32x32x16_bf16 v[240:255], v[92:95], v[204:207], v[240:255]
    buffer_load_dwordx4 v[204:207], v27, s[56:59], s6 offen sc1
    s_add_u32 s6, s6, 1024
    s_cmp_eq_u32 s6, s8
    s_cselect_b32 s6, s7, s6
    s_waitcnt vmcnt(9)
    v_mfma_f32_32x32x16_bf16 v[224:239], v[96:99], v[208:211], v[224:239]
    v_mfma_f32_32x32x16_bf16 v[240:255], v[100:103], v[208:211], v[240:255]
    buffer_load_dwordx4 v[208:211], v27, s[56:59], s6 offen sc1
    s_add_u32 s6, s6, 1024
    s_cmp_eq_u32 s6, s8
    s_cselect_b32 s6, s7, s6
    s_waitcnt vmcnt(9)
    v_mfma_f32_32x32x16_bf16 v[224:239], v[104:107], v[212:215], v[224:239]
    v_mfma_f32_32x32x16_bf16 v[240:255], v[108:111], v[212:215], v[240:255]
    buffer_load_dwordx4 v[212:215], v27, s[56:59], s6 offen sc1
    s_add_u32 s6, s6, 1024
    s_cmp_eq_u32 s6, s8
    s_cselect_b32 s6, s7, s6
    s_waitcnt vmcnt(9)
    v_mfma_f32_32x32x16_bf16 v[224:239], v[112:115], v[176:179], v[224:239]
    v_mfma_f32_32x32x16_bf16 v[240:255], v[116:119], v[176:179], v[240:255]
    buffer_load_dwordx4 v[176:179], v27, s[56:59], s6 offen sc1
    s_add_u32 s6, s6, 1024
    s_cmp_eq_u32 s6, s8
    s_cselect_b32 s6, s7, s6
    s_waitcnt vmcnt(9)
    v_mfma_f32_32x32x16_bf16 v[224:239], v[120:123], v[180:183], v[224:239]
    v_mfma_f32_32x32x16_bf16 v[240:255], v[124:127], v[180:183], v[240:255]
    buffer_load_dwordx4 v[180:183], v27, s[56:59], s6 offen sc1
    s_add_u32 s6, s6, 1024
    s_cmp_eq_u32 s6, s8
    s_cselect_b32 s6, s7, s6
    s_waitcnt vmcnt(9)
    v_mfma_f32_32x32x16_bf16 v[224:239], v[128:131], v[184:187], v[224:239]
    ds_read_b32 v3, v28 offset:16
    v_mfma_f32_32x32x16_bf16 v[240:255], v[132:135], v[184:187], v[240:255]
    buffer_load_dwordx4 v[184:187], v27, s[56:59], s6 offen sc1
    s_add_u32 s6, s6, 1024
    s_cmp_eq_u32 s6, s8
    s_cselect_b32 s6, s7, s6
    s_waitcnt vmcnt(9)
    v_mfma_f32_32x32x16_bf16 v[224:239], v[136:139], v[188:191], v[224:239]
    v_mfma_f32_32x32x16_bf16 v[240:255], v[140:143], v[188:191], v[240:255]
    buffer_load_dwordx4 v[188:191], v27, s[56:59], s6 offen sc1
    s_add_u32 s6, s6, 1024
    s_cmp_eq_u32 s6, s8
    s_cselect_b32 s6, s7, s6
    s_waitcnt lgkmcnt(0)
    v_readfirstlane_b32 s78, v3
    s_cmp_ge_u32 s78, 2
    s_cbranch_scc1 POK_16
    s_mov_b32 s79, 524288
SPIN_17:
    ds_read_b32 v3, v28 offset:16
    s_waitcnt lgkmcnt(0)
    v_readfirstlane_b32 s78, v3
    s_cmp_ge_u32 s78, 2
    s_cbranch_scc1 SPINX_18
    s_sub_u32 s79, s79, 1
    s_cmp_lg_u32 s79, 0
    s_cbranch_scc1 SPIN_17
SPINX_18:
POK_16:
    s_waitcnt vmcnt(9)
    v_mfma_f32_32x32x16_bf16 v[224:239], v[144:147], v[192:195], v[224:239]
    ds_read_b64_tr_b16 v[32:33], v8 offset:16384
    ds_read_b64_tr_b16 v[34:35], v8 offset:20480
    v_mfma_f32_32x32x16_bf16 v[240:255], v[148:151], v[192:195], v[240:255]
    ds_read_b64_tr_b16 v[36:37], v9 offset:16384
    ds_read_b64_tr_b16 v[38:39], v9 offset:20480
    buffer_load_dwordx4 v[192:195], v27, s[56:59], s6 offen sc1
    s_add_u32 s6, s6, 1024
    s_cmp_eq_u32 s6, s8
    s_cselect_b32 s6, s7, s6
    s_waitcnt vmcnt(9)
    v_mfma_f32_32x32x16_bf16 v[224:239], v[152:155], v[196:199], v[224:239]
    ds_read_b64_tr_b16 v[40:41], v8 offset:17408
    ds_read_b64_tr_b16 v[42:43], v8 offset:21504
    v_mfma_f32_32x32x16_bf16 v[240:255], v[156:159], v[196:199], v[240:255]
    ds_read_b64_tr_b16 v[44:45], v9 offset:17408
    ds_read_b64_tr_b16 v[46:47], v9 offset:21504
    buffer_load_dwordx4 v[196:199], v27, s[56:59], s6 offen sc1
    s_add_u32 s6, s6, 1024
    s_cmp_eq_u32 s6, s8
    s_cselect_b32 s6, s7, s6
    s_waitcnt vmcnt(9) lgkmcnt(6)
    v_mfma_f32_32x32x16_bf16 v[224:239], v[32:35], v[200:203], v[224:239]
    ds_read_b64_tr_b16 v[48:49], v8 offset:18432
    ds_read_b64_tr_b16 v[50:51], v8 offset:22528
    s_waitcnt lgkmcnt(6)
    v_mfma_f32_32x32x16_bf16 v[240:255], v[36:39], v[200:203], v[240:255]
    ds_read_b64_tr_b16 v[52:53], v9 offset:18432
    ds_read_b64_tr_b16 v[54:55], v9 offset:22528
    buffer_load_dwordx4 v[200:203], v27, s[56:59], s6 offen sc1
    s_add_u32 s6, s6, 1024
    s_cmp_eq_u32 s6, s8
    s_cselect_b32 s6, s7, s6
    s_waitcnt vmcnt(9) lgkmcnt(6)
    v_mfma_f32_32x32x16_bf16 v[224:239], v[40:43], v[204:207], v[224:239]
    ds_read_b64_tr_b16 v[32:33], v8 offset:19456
    ds_read_b64_tr_b16 v[34:35], v8 offset:23552
    s_waitcnt lgkmcnt(6)
    v_mfma_f32_32x32x16_bf16 v[240:255], v[44:47], v[204:207], v[240:255]
    ds_read_b64_tr_b16 v[36:37], v9 offset:19456
    ds_read_b64_tr_b16 v[38:39], v9 offset:23552
    buffer_load_dwordx4 v[204:207], v27, s[56:59], s6 offen sc1
    s_add_u32 s6, s6, 1024
    s_cmp_eq_u32 s6, s8
    s_cselect_b32 s6, s7, s6
    s_waitcnt vmcnt(9) lgkmcnt(6)
    v_mfma_f32_32x32x16_bf16 v[224:239], v[48:51], v[208:211], v[224:239]
    ds_read_b64_tr_b16 v[40:41], v10 offset:12288
    ds_read_b64_tr_b16 v[42:43], v10 offset:15360
    s_waitcnt lgkmcnt(6)
    v_mfma_f32_32x32x16_bf16 v[240:255], v[52:55], v[208:211], v[240:255]
    ds_read_b64_tr_b16 v[44:45], v11 offset:12288
    ds_read_b64_tr_b16 v[46:47], v11 offset:15360
    buffer_load_dwordx4 v[208:211], v27, s[56:59], s6 offen sc1
    s_add_u32 s6, s6, 1024
    s_cmp_eq_u32 s6, s8
    s_cselect_b32 s6, s7, s6
    s_waitcnt vmcnt(9) lgkmcnt(6)
    v_mfma_f32_32x32x16_bf16 v[224:239], v[32:35], v[212:215], v[224:239]
    ds_read_b64_tr_b16 v[48:49], v10 offset:13312
    ds_read_b64_tr_b16 v[50:51], v10 offset:16384
    s_waitcnt lgkmcnt(6)
    v_mfma_f32_32x32x16_bf16 v[240:255], v[36:39], v[212:215], v[240:255]
    ds_read_b64_tr_b16 v[52:53], v11 offset:13312
    ds_read_b64_tr_b16 v[54:55], v11 offset:16384
    buffer_load_dwordx4 v[212:215], v27, s[56:59], s6 offen sc1
    s_add_u32 s6, s6, 1024
    s_cmp_eq_u32 s6, s8
    s_cselect_b32 s6, s7, s6
    s_waitcnt vmcnt(9) lgkmcnt(6)
    v_mfma_f32_32x32x16_bf16 v[224:239], v[40:43], v[176:179], v[224:239]
    ds_read_b64_tr_b16 v[32:33], v10 offset:14336
    ds_read_b64_tr_b16 v[34:35], v10 offset:17408
    s_waitcnt lgkmcnt(6)
    v_mfma_f32_32x32x16_bf16 v[240:255], v[44:47], v[176:179], v[240:255]
    ds_read_b64_tr_b16 v[36:37], v11 offset:14336
    ds_read_b64_tr_b16 v[38:39], v11 offset:17408
    buffer_load_dwordx4 v[176:179], v27, s[56:59], s6 offen sc1
    s_add_u32 s6, s6, 1024
    s_cmp_eq_u32 s6, s8
    s_cselect_b32 s6, s7, s6
    s_waitcnt vmcnt(9) lgkmcnt(6)
    v_mfma_f32_32x32x16_bf16 v[224:239], v[48:51], v[180:183], v[224:239]
    ds_read_b64_tr_b16 v[40:41], v10 offset:49184
    ds_read_b64_tr_b16 v[42:43], v10 offset:52256
    s_waitcnt lgkmcnt(6)
    v_mfma_f32_32x32x16_bf16 v[240:255], v[52:55], v[180:183], v[240:255]
    ds_read_b64_tr_b16 v[44:45], v11 offset:49184
    ds_read_b64_tr_b16 v[46:47], v11 offset:52256
    buffer_load_dwordx4 v[180:183], v27, s[56:59], s6 offen sc1
    s_add_u32 s6, s6, 1024
    s_cmp_eq_u32 s6, s8
    s_cselect_b32 s6, s7, s6
    s_waitcnt vmcnt(9) lgkmcnt(6)
    v_mfma_f32_32x32x16_bf16 v[224:239], v[32:35], v[184:187], v[224:239]
    ds_read_b64_tr_b16 v[48:49], v10 offset:50208
    ds_read_b64_tr_b16 v[50:51], v10 offset:53280
    s_waitcnt lgkmcnt(6)
    v_mfma_f32_32x32x16_bf16 v[240:255], v[36:39], v[184:187], v[240:255]
    ds_read_b64_tr_b16 v[52:53], v11 offset:50208
    ds_read_b64_tr_b16 v[54:55], v11 offset:53280
    buffer_load_dwordx4 v[184:187], v27, s[56:59], s6 offen sc1
    s_add_u32 s6, s6, 1024
    s_cmp_eq_u32 s6, s8
    s_cselect_b32 s6, s7, s6
    s_waitcnt vmcnt(9) lgkmcnt(6)
    v_mfma_f32_32x32x16_bf16 v[224:239], v[40:43], v[188:191], v[224:239]
    ds_read_b64_tr_b16 v[32:33], v10 offset:51232
    ds_read_b64_tr_b16 v[34:35], v10 offset:54304
    s_waitcnt lgkmcnt(6)
    v_mfma_f32_32x32x16_bf16 v[240:255], v[44:47], v[188:191], v[240:255]
    ds_read_b64_tr_b16 v[36:37], v11 offset:51232
    ds_read_b64_tr_b16 v[38:39], v11 offset:54304
    buffer_load_dwordx4 v[188:191], v27, s[56:59], s6 offen sc1
    s_add_u32 s6, s6, 1024
    s_cmp_eq_u32 s6, s8
    s_cselect_b32 s6, s7, s6
    s_waitcnt vmcnt(9) lgkmcnt(6)
    v_mfma_f32_32x32x16_bf16 v[224:239], v[48:51], v[192:195], v[224:239]
    ds_read_b64_tr_b16 v[40:41], v12 offset:0
    ds_read_b64_tr_b16 v[42:43], v12 offset:1024
    s_waitcnt lgkmcnt(6)
    v_mfma_f32_32x32x16_bf16 v[240:255], v[52:55], v[192:195], v[240:255]
    ds_read_b64_tr_b16 v[44:45], v13 offset:0
    ds_read_b64_tr_b16 v[46:47], v13 offset:1024
    buffer_load_dwordx4 v[192:195], v27, s[56:59], s6 offen sc1
    s_add_u32 s6, s6, 1024
    s_cmp_eq_u32 s6, s8
    s_cselect_b32 s6, s7, s6
    s_mov_b64 exec, 1
    ds_add_u32 v28, v7 offset:32
    s_mov_b64 exec, -1
    s_waitcnt vmcnt(9) lgkmcnt(7)
    v_mfma_f32_32x32x16_bf16 v[224:239], v[32:35], v[196:199], v[224:239]
    ds_read_b64_tr_b16 v[48:49], v8 offset:32768
    ds_read_b64_tr_b16 v[50:51], v8 offset:36864
    s_waitcnt lgkmcnt(7)
    v_mfma_f32_32x32x16_bf16 v[240:255], v[36:39], v[196:199], v[240:255]
    ds_read_b64_tr_b16 v[52:53], v9 offset:32768
    ds_read_b64_tr_b16 v[54:55], v9 offset:36864
    buffer_load_dwordx4 v[196:199], v27, s[56:59], s6 offen sc1
    s_add_u32 s6, s6, 1024
    s_cmp_eq_u32 s6, s8
    s_cselect_b32 s6, s7, s6
    s_waitcnt vmcnt(9) lgkmcnt(7)
    v_mfma_f32_32x32x16_bf16 v[224:239], v[40:43], v[200:203], v[224:239]
    ds_read_b64_tr_b16 v[32:33], v8 offset:33792
    ds_read_b64_tr_b16 v[34:35], v8 offset:37888
    s_waitcnt lgkmcnt(7)
    v_mfma_f32_32x32x16_bf16 v[240:255], v[44:47], v[200:203], v[240:255]
    ds_read_b64_tr_b16 v[36:37], v9 offset:33792
    ds_read_b64_tr_b16 v[38:39], v9 offset:37888
    buffer_load_dwordx4 v[200:203], v27, s[56:59], s6 offen sc1
    s_add_u32 s6, s6, 1024
    s_cmp_eq_u32 s6, s8
    s_cselect_b32 s6, s7, s6
    s_waitcnt vmcnt(9) lgkmcnt(6)
    v_mfma_f32_32x32x16_bf16 v[224:239], v[48:51], v[204:207], v[224:239]
    ds_read_b64_tr_b16 v[40:41], v8 offset:34816
    ds_read_b64_tr_b16 v[42:43], v8 offset:38912
    s_waitcnt lgkmcnt(6)
    v_mfma_f32_32x32x16_bf16 v[240:255], v[52:55], v[204:207], v[240:255]
    ds_read_b64_tr_b16 v[44:45], v9 offset:34816
    ds_read_b64_tr_b16 v[46:47], v9 offset:38912
    buffer_load_dwordx4 v[204:207], v27, s[56:59], s6 offen sc1
    s_add_u32 s6, s6, 1024
    s_cmp_eq_u32 s6, s8
    s_cselect_b32 s6, s7, s6
    s_waitcnt vmcnt(9) lgkmcnt(6)
    v_mfma_f32_32x32x16_bf16 v[224:239], v[32:35], v[208:211], v[224:239]
    ds_read_b64_tr_b16 v[48:49], v8 offset:35840
    ds_read_b64_tr_b16 v[50:51], v8 offset:39936
    s_waitcnt lgkmcnt(6)
    v_mfma_f32_32x32x16_bf16 v[240:255], v[36:39], v[208:211], v[240:255]
    ds_read_b64_tr_b16 v[52:53], v9 offset:35840
    ds_read_b64_tr_b16 v[54:55], v9 offset:39936
    buffer_load_dwordx4 v[208:211], v27, s[56:59], s6 offen sc1
    s_add_u32 s6, s6, 1024
    s_cmp_eq_u32 s6, s8
    s_cselect_b32 s6, s7, s6
    s_waitcnt vmcnt(9) lgkmcnt(6)
    v_mfma_f32_32x32x16_bf16 v[224:239], v[40:43], v[212:215], v[224:239]
    ds_read_b64_tr_b16 v[32:33], v12 offset:4096
    ds_read_b64_tr_b16 v[34:35], v12 offset:5120
    ds_read_b32 v4, v28 offset:112
    s_waitcnt lgkmcnt(7)
    v_mfma_f32_32x32x16_bf16 v[240:255], v[44:47], v[212:215], v[240:255]
    ds_read_b64_tr_b16 v[36:37], v13 offset:4096
    ds_read_b64_tr_b16 v[38:39], v13 offset:5120
    buffer_load_dwordx4 v[212:215], v27, s[56:59], s6 offen sc1
    s_add_u32 s6, s6, 1024
    s_cmp_eq_u32 s6, s8
    s_cselect_b32 s6, s7, s6
    s_waitcnt vmcnt(9) lgkmcnt(7)
    v_mfma_f32_32x32x16_bf16 v[224:239], v[48:51], v[176:179], v[224:239]
    ds_read_b64_tr_b16 v[40:41], v12 offset:8192
    ds_read_b64_tr_b16 v[42:43], v12 offset:9216
    s_waitcnt lgkmcnt(4)
    v_readfirstlane_b32 s78, v4
    s_cmp_ge_u32 s78, 2
    s_cbranch_scc1 POK_19
    s_mov_b32 s79, 524288
SPIN_20:
    ds_read_b32 v4, v28 offset:112
    s_waitcnt lgkmcnt(0)
    v_readfirstlane_b32 s78, v4
    s_cmp_ge_u32 s78, 2
    s_cbranch_scc1 SPINX_21
    s_sub_u32 s79, s79, 1
    s_cmp_lg_u32 s79, 0
    s_cbranch_scc1 SPIN_20
SPINX_21:
POK_19:
    v_mfma_f32_32x32x16_bf16 v[240:255], v[52:55], v[176:179], v[240:255]
    ds_read_b64_tr_b16 v[44:45], v13 offset:8192
    ds_read_b64_tr_b16 v[46:47], v13 offset:9216
    buffer_load_dwordx4 v[176:179], v27, s[56:59], s6 offen sc1
    s_add_u32 s6, s6, 1024
    s_cmp_eq_u32 s6, s8
    s_cselect_b32 s6, s7, s6
    ds_read_b64 v[56:57], v161
    ds_read_b64 v[58:59], v162
    ds_read_b64 v[60:61], v163
    ds_read_b64 v[62:63], v164
    s_waitcnt vmcnt(9)
    v_mfma_f32_32x32x16_bf16 v[224:239], v[32:35], v[180:183], v[224:239]
    ds_read_b64_tr_b16 v[48:49], v8 offset:0
    ds_read_b64_tr_b16 v[50:51], v8 offset:4096
    s_waitcnt lgkmcnt(10)
    v_mfma_f32_32x32x16_bf16 v[240:255], v[36:39], v[180:183], v[240:255]
    ds_read_b64_tr_b16 v[52:53], v9 offset:0
    ds_read_b64_tr_b16 v[54:55], v9 offset:4096
    buffer_load_dwordx4 v[180:183], v27, s[56:59], s6 offen sc1
    s_add_u32 s6, s6, 1024
    s_cmp_eq_u32 s6, s8
    s_cselect_b32 s6, s7, s6
    s_waitcnt vmcnt(9) lgkmcnt(10)
    v_mfma_f32_32x32x16_bf16 v[224:239], v[40:43], v[184:187], v[224:239]
    ds_read_b64_tr_b16 v[32:33], v8 offset:1024
    ds_read_b64_tr_b16 v[34:35], v8 offset:5120
    s_waitcnt lgkmcnt(9)
    v_lshlrev_b32 v72, 16, v56
    v_and_b32 v73, 0xffff0000, v56
    v_mfma_f32_32x32x16_bf16 v[240:255], v[44:47], v[184:187], v[240:255]
    ds_read_b64_tr_b16 v[36:37], v9 offset:1024
    ds_read_b64_tr_b16 v[38:39], v9 offset:5120
    buffer_load_dwordx4 v[184:187], v27, s[56:59], s6 offen sc1
    v_lshlrev_b32 v74, 16, v57
    v_and_b32 v75, 0xffff0000, v57
    s_waitcnt vmcnt(9) lgkmcnt(6)
    v_mfma_f32_32x32x16_bf16 v[224:239], v[48:51], v[188:191], v[224:239]
    ds_read_b64_tr_b16 v[40:41], v8 offset:2048
    ds_read_b64_tr_b16 v[42:43], v8 offset:6144
    v_lshlrev_b32 v76, 16, v58
    v_and_b32 v77, 0xffff0000, v58
    s_waitcnt lgkmcnt(6)
    v_mfma_f32_32x32x16_bf16 v[240:255], v[52:55], v[188:191], v[240:255]
    ds_read_b64_tr_b16 v[44:45], v9 offset:2048
    ds_read_b64_tr_b16 v[46:47], v9 offset:6144
    v_lshlrev_b32 v78, 16, v59
    v_and_b32 v79, 0xffff0000, v59
    s_waitcnt vmcnt(8) lgkmcnt(6)
    v_mfma_f32_32x32x16_bf16 v[224:239], v[32:35], v[192:195], v[224:239]
    ds_read_b64_tr_b16 v[48:49], v8 offset:3072
    ds_read_b64_tr_b16 v[50:51], v8 offset:7168
    v_lshlrev_b32 v80, 16, v60
    v_and_b32 v81, 0xffff0000, v60
    s_waitcnt lgkmcnt(6)
    v_mfma_f32_32x32x16_bf16 v[240:255], v[36:39], v[192:195], v[240:255]
    ds_read_b64_tr_b16 v[52:53], v9 offset:3072
    ds_read_b64_tr_b16 v[54:55], v9 offset:7168
    v_lshlrev_b32 v82, 16, v61
    v_and_b32 v83, 0xffff0000, v61
    s_waitcnt vmcnt(7) lgkmcnt(6)
    v_mfma_f32_32x32x16_bf16 v[224:239], v[40:43], v[196:199], v[224:239]
    ds_read_b64_tr_b16 v[32:33], v10 offset:0
    ds_read_b64_tr_b16 v[34:35], v10 offset:3072
    v_lshlrev_b32 v84, 16, v62
    v_and_b32 v85, 0xffff0000, v62
    s_waitcnt lgkmcnt(6)
    v_mfma_f32_32x32x16_bf16 v[240:255], v[44:47], v[196:199], v[240:255]
    ds_read_b64_tr_b16 v[36:37], v11 offset:0
    ds_read_b64_tr_b16 v[38:39], v11 offset:3072
    v_lshlrev_b32 v86, 16, v63
    v_and_b32 v87, 0xffff0000, v63
    s_waitcnt vmcnt(6) lgkmcnt(6)
    v_mfma_f32_32x32x16_bf16 v[224:239], v[48:51], v[200:203], v[224:239]
    ds_read_b64_tr_b16 v[40:41], v10 offset:1024
    ds_read_b64_tr_b16 v[42:43], v10 offset:4096
    s_waitcnt lgkmcnt(6)
    v_mfma_f32_32x32x16_bf16 v[240:255], v[52:55], v[200:203], v[240:255]
    ds_read_b64_tr_b16 v[44:45], v11 offset:1024
    ds_read_b64_tr_b16 v[46:47], v11 offset:4096
    s_waitcnt vmcnt(5) lgkmcnt(6)
    v_mfma_f32_32x32x16_bf16 v[224:239], v[32:35], v[204:207], v[224:239]
    ds_read_b64_tr_b16 v[48:49], v10 offset:2048
    ds_read_b64_tr_b16 v[50:51], v10 offset:5120
    s_waitcnt lgkmcnt(6)
    v_mfma_f32_32x32x16_bf16 v[240:255], v[36:39], v[204:207], v[240:255]
    ds_read_b64_tr_b16 v[52:53], v11 offset:2048
    ds_read_b64_tr_b16 v[54:55], v11 offset:5120
    s_waitcnt vmcnt(4) lgkmcnt(6)
    v_mfma_f32_32x32x16_bf16 v[224:239], v[40:43], v[208:211], v[224:239]
    ds_read_b64_tr_b16 v[32:33], v10 offset:36896
    ds_read_b64_tr_b16 v[34:35], v10 offset:39968
    s_waitcnt lgkmcnt(6)
    v_mfma_f32_32x32x16_bf16 v[240:255], v[44:47], v[208:211], v[240:255]
    ds_read_b64_tr_b16 v[36:37], v11 offset:36896
    ds_read_b64_tr_b16 v[38:39], v11 offset:39968
    s_waitcnt vmcnt(3) lgkmcnt(6)
    v_mfma_f32_32x32x16_bf16 v[224:239], v[48:51], v[212:215], v[224:239]
    ds_read_b64_tr_b16 v[40:41], v10 offset:37920
    ds_read_b64_tr_b16 v[42:43], v10 offset:40992
    s_waitcnt lgkmcnt(6)
    v_mfma_f32_32x32x16_bf16 v[240:255], v[52:55], v[212:215], v[240:255]
    ds_read_b64_tr_b16 v[44:45], v11 offset:37920
    ds_read_b64_tr_b16 v[46:47], v11 offset:40992
    s_waitcnt vmcnt(2) lgkmcnt(6)
    v_mfma_f32_32x32x16_bf16 v[224:239], v[32:35], v[176:179], v[224:239]
    ds_read_b64_tr_b16 v[48:49], v10 offset:38944
    ds_read_b64_tr_b16 v[50:51], v10 offset:42016
    ds_read_b32 v4, v28 offset:32
    s_waitcnt lgkmcnt(7)
    v_mfma_f32_32x32x16_bf16 v[240:255], v[36:39], v[176:179], v[240:255]
    ds_read_b64_tr_b16 v[52:53], v11 offset:38944
    ds_read_b64_tr_b16 v[54:55], v11 offset:42016
    s_waitcnt vmcnt(1) lgkmcnt(7)
    v_mfma_f32_32x32x16_bf16 v[224:239], v[40:43], v[180:183], v[224:239]
    s_waitcnt lgkmcnt(5)
    v_mfma_f32_32x32x16_bf16 v[240:255], v[44:47], v[180:183], v[240:255]
    s_waitcnt lgkmcnt(2)
    v_readfirstlane_b32 s78, v4
    s_cmp_ge_u32 s78, 2
    s_cbranch_scc1 POK_22
    s_mov_b32 s79, 524288
SPIN_23:
    ds_read_b32 v4, v28 offset:32
    s_waitcnt lgkmcnt(0)
    v_readfirstlane_b32 s78, v4
    s_cmp_ge_u32 s78, 2
    s_cbranch_scc1 SPINX_24
    s_sub_u32 s79, s79, 1
    s_cmp_lg_u32 s79, 0
    s_cbranch_scc1 SPIN_23
SPINX_24:
POK_22:
    s_waitcnt vmcnt(0) lgkmcnt(0)
    v_mfma_f32_32x32x16_bf16 v[240:255], v[52:55], v[184:187], v[240:255]
    v_mfma_f32_32x32x16_bf16 v[224:239], v[48:51], v[184:187], v[224:239]
    s_nop 10
    ds_write_b128 v5, v[240:243] offset:0
    ds_write_b128 v5, v[244:247] offset:1024
    ds_write_b128 v5, v[248:251] offset:2048
    ds_write_b128 v5, v[252:255] offset:3072
    s_movk_i32 s66, 0x3f80
    s_mov_b32 s67, 0x3f800000
    v_pk_fma_f32 v[72:73], v[224:225], v[160:161], v[72:73] op_sel_hi:[1,0,1]
    v_pk_fma_f32 v[74:75], v[226:227], v[160:161], v[74:75] op_sel_hi:[1,0,1]
    v_pk_fma_f32 v[76:77], v[228:229], v[160:161], v[76:77] op_sel_hi:[1,0,1]
    v_pk_fma_f32 v[78:79], v[230:231], v[160:161], v[78:79] op_sel_hi:[1,0,1]
    v_pk_fma_f32 v[80:81], v[232:233], v[160:161], v[80:81] op_sel_hi:[1,0,1]
    v_pk_fma_f32 v[82:83], v[234:235], v[160:161], v[82:83] op_sel_hi:[1,0,1]
    v_pk_fma_f32 v[84:85], v[236:237], v[160:161], v[84:85] op_sel_hi:[1,0,1]
    v_pk_fma_f32 v[86:87], v[238:239], v[160:161], v[86:87] op_sel_hi:[1,0,1]
    s_waitcnt lgkmcnt(0)
    s_barrier
    ds_read_b64_tr_b16 v[88:89], v14 offset:0
    ds_read_b128 v[96:99], v6 offset:0
    ds_read_b64_tr_b16 v[90:91], v14 offset:1024
    ds_read_b128 v[100:103], v6 offset:1024
    ds_read_b64_tr_b16 v[92:93], v14 offset:2048
    ds_read_b128 v[104:107], v6 offset:2048
    ds_read_b64_tr_b16 v[94:95], v14 offset:3072
    ds_read_b128 v[108:111], v6 offset:3072
    s_waitcnt lgkmcnt(7)
    v_dot2_f32_bf16 v72, v88, s66, v72
    v_dot2_f32_bf16 v73, v88, s67, v73
    v_dot2_f32_bf16 v74, v89, s66, v74
    v_dot2_f32_bf16 v75, v89, s67, v75
    s_waitcnt lgkmcnt(5)
    v_dot2_f32_bf16 v76, v90, s66, v76
    v_dot2_f32_bf16 v77, v90, s67, v77
    v_dot2_f32_bf16 v78, v91, s66, v78
    v_dot2_f32_bf16 v79, v91, s67, v79
    v_pk_fma_f32 v[72:73], v[96:97], v[160:161], v[72:73] op_sel_hi:[1,0,1]
    v_pk_fma_f32 v[74:75], v[98:99], v[160:161], v[74:75] op_sel_hi:[1,0,1]
    s_waitcnt lgkmcnt(4)
    v_pk_fma_f32 v[76:77], v[100:101], v[160:161], v[76:77] op_sel_hi:[1,0,1]
    v_pk_fma_f32 v[78:79], v[102:103], v[160:161], v[78:79] op_sel_hi:[1,0,1]
    v_cvt_pk_bf16_f32 v56, v72, v73
    v_cvt_pk_bf16_f32 v57, v74, v75
    v_cvt_pk_bf16_f32 v58, v76, v77
    v_cvt_pk_bf16_f32 v59, v78, v79
    s_nop 0
    v_permlane32_swap_b32 v56, v58
    v_permlane32_swap_b32 v57, v59
    buffer_store_dwordx4 v[56:59], v15, s[52:55], 0 offen offset:0
    s_waitcnt lgkmcnt(3)
    v_dot2_f32_bf16 v80, v92, s66, v80
    v_dot2_f32_bf16 v81, v92, s67, v81
    v_dot2_f32_bf16 v82, v93, s66, v82
    v_dot2_f32_bf16 v83, v93, s67, v83
    s_waitcnt lgkmcnt(1)
    v_dot2_f32_bf16 v84, v94, s66, v84
    v_dot2_f32_bf16 v85, v94, s67, v85
    v_dot2_f32_bf16 v86, v95, s66, v86
    v_dot2_f32_bf16 v87, v95, s67, v87
    v_pk_fma_f32 v[80:81], v[104:105], v[160:161], v[80:81] op_sel_hi:[1,0,1]
    v_pk_fma_f32 v[82:83], v[106:107], v[160:161], v[82:83] op_sel_hi:[1,0,1]
    s_waitcnt lgkmcnt(0)
    v_pk_fma_f32 v[84:85], v[108:109], v[160:161], v[84:85] op_sel_hi:[1,0,1]
    v_pk_fma_f32 v[86:87], v[110:111], v[160:161], v[86:87] op_sel_hi:[1,0,1]
    v_cvt_pk_bf16_f32 v60, v80, v81
    v_cvt_pk_bf16_f32 v61, v82, v83
    v_cvt_pk_bf16_f32 v62, v84, v85
    v_cvt_pk_bf16_f32 v63, v86, v87
    s_nop 0
    v_permlane32_swap_b32 v60, v62
    v_permlane32_swap_b32 v61, v63
    buffer_store_dwordx4 v[60:63], v15, s[52:55], 0 offen offset:32
    s_endpgm
L_S:
    s_sub_u32 s74, s3, 4
    s_lshr_b32 s75, s74, 1
    s_and_b32 s77, s74, 1
    s_lshr_b32 s66, s2, 3
    s_lshl_b32 s66, s66, 1
    s_add_u32 s66, s66, s75
    s_lshl_b32 s66, s66, 3
    s_and_b32 s67, s2, 7
    s_add_u32 s73, s66, s67
    s_lshl_b32 s67, s73, 8
    s_lshl_b32 s68, s77, 7
    s_add_u32 s67, s67, s68
    v_lshl_add_u32 v18, v0, 1, s67
    s_lshl_b32 s66, s73, 1
    v_mov_b32 v19, s66
    s_and_b32 s66, s62, 1
    s_lshl_b32 s67, s66, 2
    v_and_b32 v1, 7, v0
    v_lshrrev_b32 v2, 4, v0
    v_xor_b32 v1, v1, v2
    v_xor_b32 v1, s67, v1
    v_lshrrev_b32 v2, 3, v0
    s_lshl_b32 s68, s74, 15
    s_lshl_b32 s69, s62, 17
    s_add_u32 s68, s68, s69
    v_lshl_add_u32 v2, v2, 10, s68
    v_lshl_add_u32 v10, v1, 4, v2
    v_xor_b32 v1, 4, v1
    v_lshl_add_u32 v2, v1, 4, v2
    v_add_u32 v11, 7168, v2
    v_add_u32 v12, 14336, v10
    v_add_u32 v13, 21504, v2
    s_lshl_b32 s66, s74, 12
    s_add_u32 s66, s66, 34816
    s_mul_i32 s68, s74, 3072
    s_add_u32 s67, s68, 83968
    s_add_u32 s68, s68, 120864
    s_mul_i32 s70, s63, 192
    s_lshr_b32 s71, s62, 1
    s_lshl_b32 s76, s71, 7
    v_lshlrev_b32 v31, 4, v0
    s_waitcnt lgkmcnt(0)
    s_barrier
    global_load_ushort v38, v19, s[18:19]
    global_load_ushort v32, v18, s[6:7]
    global_load_ushort v33, v18, s[8:9]
    global_load_ushort v34, v18, s[10:11]
    global_load_ushort v35, v18, s[12:13]
    global_load_ushort v36, v18, s[14:15]
    global_load_ushort v37, v18, s[16:17]
    global_load_ushort v39, v19, s[20:21]
    s_load_dword s60, s[34:35], 0
    s_cmp_eq_u32 s63, 15
    s_mov_b32 s36, s4
    s_mov_b32 s37, s5
    s_cselect_b32 s38, 0, 0x200000
    s_mov_b32 s39, 0x20000
    s_mov_b32 s40, s24
    s_mov_b32 s41, s25
    s_cselect_b32 s42, 0, 1409024
    s_mov_b32 s43, 0x20000
    s_mov_b32 s44, s26
    s_mov_b32 s45, s27
    s_mov_b32 s46, s42
    s_mov_b32 s47, 0x20000
    s_and_b32 s32, s62, 1
    s_lshl_b32 s32, s32, 5
    s_lshl_b32 s33, s74, 4
    s_movk_i32 s31, 2752
    s_mul_i32 s23, s76, 1376
    s_add_u32 m0, s66, 0
    s_nop 0
    buffer_load_dwordx4 v10, s[36:39], s76 offen offset:0 lds
    v_add_u32 v1, 0, v0
    v_mul_u32_u24 v2, 0x5556, v1
    v_lshrrev_b32 v2, 18, v2
    v_mul_u32_u24 v3, 12, v2
    v_sub_u32 v3, v1, v3
    v_add_u32 v2, s33, v2
    v_xor_b32 v2, s32, v2
    v_lshl_add_u32 v3, v3, 4, s70
    v_mad_u32_u24 v2, v2, s31, v3
    v_subrev_u32 v14, 0, v2
    buffer_load_dwordx4 v11, s[36:39], s76 offen offset:1024 lds
    v_add_u32 v1, 64, v0
    v_mul_u32_u24 v2, 0x5556, v1
    v_lshrrev_b32 v2, 18, v2
    v_mul_u32_u24 v3, 12, v2
    v_sub_u32 v3, v1, v3
    v_add_u32 v2, s33, v2
    v_xor_b32 v2, s32, v2
    v_lshl_add_u32 v3, v3, 4, s70
    v_mad_u32_u24 v2, v2, s31, v3
    v_subrev_u32 v15, 1024, v2
    buffer_load_dwordx4 v12, s[36:39], s76 offen offset:2048 lds
    v_add_u32 v1, 128, v0
    v_mul_u32_u24 v2, 0x5556, v1
    v_lshrrev_b32 v2, 18, v2
    v_mul_u32_u24 v3, 12, v2
    v_sub_u32 v3, v1, v3
    v_add_u32 v2, s33, v2
    v_xor_b32 v2, s32, v2
    v_lshl_add_u32 v3, v3, 4, s70
    v_mad_u32_u24 v2, v2, s31, v3
    v_subrev_u32 v16, 2048, v2
    buffer_load_dwordx4 v13, s[36:39], s76 offen offset:3072 lds
    s_add_u32 m0, s67, 0
    s_add_u32 s76, s76, 128
    s_and_b32 s76, s76, 0x3ff
    s_mov_b32 s56, s34
    s_mov_b32 s57, s35
    s_mov_b32 s58, 33554432
    s_mov_b32 s59, 0x20000
    s_mov_b32 s48, s28
    s_mov_b32 s49, s29
    s_mov_b32 s50, 1409024
    s_mov_b32 s51, 0x20000
    s_lshl_b32 s22, s73, 12
    s_add_u32 s22, s22, 2359296
    buffer_load_dwordx4 v14, s[40:43], s23 offen offset:0 lds
    s_mul_i32 s25, s74, 8704
    s_add_u32 s25, s25, 0
    v_and_b32 v1, 31, v0
    buffer_load_dwordx4 v15, s[40:43], s23 offen offset:1024 lds
    v_lshrrev_b32 v2, 5, v0
    v_mul_u32_u24 v3, 272, v1
    v_lshl_add_u32 v3, v2, 4, v3
    buffer_load_dwordx4 v16, s[40:43], s23 offen offset:2048 lds
    s_add_u32 m0, s68, 0
    v_add_u32 v109, s25, v3
    v_add_u32 v110, s25, v31
    v_lshl_add_u32 v9, v0, 2, s25
    buffer_load_dwordx4 v14, s[44:47], s23 offen offset:0 lds
    v_mov_b32 v244, 163168
    v_mov_b32 v245, 1
    s_lshl_b32 s24, s75, 2
    s_add_u32 s24, s24, 163168
    buffer_load_dwordx4 v15, s[44:47], s23 offen offset:1024 lds
    v_mov_b32 v237, s24
    s_lshl_b32 s31, s64, 2
    s_add_u32 s31, s31, 11010048
    s_cmp_eq_u32 s74, 0
    s_cselect_b32 s31, s31, 1073741824
    buffer_load_dwordx4 v16, s[44:47], s23 offen offset:2048 lds
    s_add_u32 m0, s66, 16384
    s_mul_i32 s23, s76, 1376
    s_waitcnt vmcnt(17)
    v_lshlrev_b32 v38, 16, v38
    s_waitcnt vmcnt(16)
    v_lshlrev_b32 v32, 16, v32
    s_waitcnt vmcnt(15)
    v_lshlrev_b32 v33, 16, v33
    s_waitcnt vmcnt(14)
    v_lshlrev_b32 v34, 16, v34
    s_waitcnt vmcnt(13)
    v_lshlrev_b32 v35, 16, v35
    s_waitcnt vmcnt(12)
    v_lshlrev_b32 v36, 16, v36
    s_waitcnt vmcnt(11)
    v_lshlrev_b32 v37, 16, v37
    s_waitcnt vmcnt(10)
    v_lshlrev_b32 v39, 16, v39
    s_mov_b32 s24, 1069066811
    v_mul_f32 v1, s24, v38
    v_fma_f32 v2, v38, s24, -v1
    v_fmac_f32 v2, 849703008, v38
    v_exp_f32 v1, v1
    v_mul_f32 v2, 1060205080, v2
    v_fmac_f32 v1, v1, v2
    v_cvt_pk_bf16_f32 v1, v1, v1
    v_and_b32 v1, 0xffff0000, v1
    v_mul_f32 v32, v32, v1
    v_mul_f32 v33, v33, v1
    v_mul_f32 v34, v34, v1
    v_mul_f32 v35, v35, v1
    v_pk_mul_f32 v[68:69], v[36:37], v[34:35] op_sel:[0,0] op_sel_hi:[1,0]
    v_pk_fma_f32 v[42:43], v[36:37], v[34:35], v[68:69] op_sel:[1,1,0] op_sel_hi:[0,1,1] neg_lo:[1,0,0]
    v_mul_f32 v40, s24, v32
    v_mul_f32 v41, 1042479491, v33
    v_max_f32 v8, |v42|, |v43|
    v_exp_f32 v1, v40
    v_fract_f32 v2, v41
    v_max_u32_dpp v8, v8, v8 quad_perm:[1,0,3,2] row_mask:0xf bank_mask:0xf
    v_cos_f32 v3, v2
    v_sin_f32 v45, v2
    v_max_u32_dpp v8, v8, v8 quad_perm:[2,3,0,1] row_mask:0xf bank_mask:0xf
    v_mul_f32 v44, v1, v3
    v_mul_f32 v45, v1, v45
    v_mul_f32 v1, 1090519040, v40
    v_mul_f32 v2, 1090519040, v41
    v_exp_f32 v1, v1
    v_fract_f32 v2, v2
    v_max_u32_dpp v8, v8, v8 row_half_mirror row_mask:0xf bank_mask:0xf
    v_cos_f32 v3, v2
    v_sin_f32 v51, v2
    v_max_u32_dpp v8, v8, v8 row_mirror row_mask:0xf bank_mask:0xf
    v_mul_f32 v50, v1, v3
    v_mul_f32 v51, v1, v51
    v_mul_f32 v1, 1132462080, v40
    v_mul_f32 v2, 1132462080, v41
    v_exp_f32 v1, v1
    v_fract_f32 v2, v2
    v_cos_f32 v3, v2
    v_sin_f32 v61, v2
    v_mul_f32 v60, v1, v3
    v_mul_f32 v61, v1, v61
    v_readlane_b32 s26, v8, 0
    buffer_load_dwordx4 v10, s[36:39], s76 offen offset:0 lds
    v_readlane_b32 s27, v8, 16
    v_readlane_b32 s28, v8, 32
    v_readlane_b32 s29, v8, 48
    v_pk_mul_f32 v[68:69], v[44:45], v[44:45] op_sel:[0,0] op_sel_hi:[1,0]
    v_pk_fma_f32 v[46:47], v[44:45], v[44:45], v[68:69] op_sel:[1,1,0] op_sel_hi:[0,1,1] neg_lo:[1,0,0]
    buffer_load_dwordx4 v11, s[36:39], s76 offen offset:1024 lds
    v_pk_mul_f32 v[70:71], v[60:61], v[60:61] op_sel:[0,0] op_sel_hi:[1,0]
    v_pk_fma_f32 v[62:63], v[60:61], v[60:61], v[70:71] op_sel:[1,1,0] op_sel_hi:[0,1,1] neg_lo:[1,0,0]
    s_max_u32 s26, s26, s27
    s_max_u32 s28, s28, s29
    s_max_u32 s26, s26, s28
    s_lshr_b32 s26, s26, 23
    s_sub_u32 s26, 266, s26
    s_min_u32 s26, s26, 253
    s_sub_u32 s27, 254, s26
    s_lshl_b32 s27, s27, 23
    s_lshl_b32 s26, s26, 23
    v_pk_mul_f32 v[68:69], v[46:47], v[46:47] op_sel:[0,0] op_sel_hi:[1,0]
    buffer_load_dwordx4 v12, s[36:39], s76 offen offset:2048 lds
    v_pk_fma_f32 v[48:49], v[46:47], v[46:47], v[68:69] op_sel:[1,1,0] op_sel_hi:[0,1,1] neg_lo:[1,0,0]
    v_pk_mul_f32 v[70:71], v[62:63], v[62:63] op_sel:[0,0] op_sel_hi:[1,0]
    v_pk_fma_f32 v[64:65], v[62:63], v[62:63], v[70:71] op_sel:[1,1,0] op_sel_hi:[0,1,1] neg_lo:[1,0,0]
    v_mul_f32 v42, s26, v42
    v_mul_f32 v43, s26, v43
    buffer_load_dwordx4 v13, s[36:39], s76 offen offset:3072 lds
    s_add_u32 m0, s67, 12288
    s_add_u32 s76, s76, 128
    s_and_b32 s76, s76, 0x3ff
    v_pk_mul_f32 v[68:69], v[50:51], v[50:51] op_sel:[0,0] op_sel_hi:[1,0]
    v_pk_fma_f32 v[52:53], v[50:51], v[50:51], v[68:69] op_sel:[1,1,0] op_sel_hi:[0,1,1] neg_lo:[1,0,0]
    v_pk_mul_f32 v[70:71], v[64:65], v[64:65] op_sel:[0,0] op_sel_hi:[1,0]
    v_pk_fma_f32 v[66:67], v[64:65], v[64:65], v[70:71] op_sel:[1,1,0] op_sel_hi:[0,1,1] neg_lo:[1,0,0]
    v_cvt_pk_f16_f32 v72, v42, -v43
    buffer_load_dwordx4 v14, s[40:43], s23 offen offset:0 lds
    v_cvt_pk_f16_f32 v73, v44, -v45
    v_cvt_pk_f16_f32 v76, v60, -v61
    v_cvt_pk_f16_f32 v74, v46, -v47
    v_pk_mul_f32 v[68:69], v[52:53], v[52:53] op_sel:[0,0] op_sel_hi:[1,0]
    v_pk_fma_f32 v[54:55], v[52:53], v[52:53], v[68:69] op_sel:[1,1,0] op_sel_hi:[0,1,1] neg_lo:[1,0,0]
    buffer_load_dwordx4 v15, s[40:43], s23 offen offset:1024 lds
    v_cvt_pk_f16_f32 v77, v62, -v63
    v_cvt_pk_f16_f32 v75, v48, -v49
    v_pk_mul_f32 v[68:69], v[54:55], v[54:55] op_sel:[0,0] op_sel_hi:[1,0]
    v_pk_fma_f32 v[56:57], v[54:55], v[54:55], v[68:69] op_sel:[1,1,0] op_sel_hi:[0,1,1] neg_lo:[1,0,0]
    v_cvt_pk_f16_f32 v78, v64, -v65
    buffer_load_dwordx4 v16, s[40:43], s23 offen offset:2048 lds
    s_add_u32 m0, s68, 12288
    v_cvt_pk_f16_f32 v79, v66, -v67
    v_pk_mul_f32 v[68:69], v[56:57], v[56:57] op_sel:[0,0] op_sel_hi:[1,0]
    v_pk_fma_f32 v[58:59], v[56:57], v[56:57], v[68:69] op_sel:[1,1,0] op_sel_hi:[0,1,1] neg_lo:[1,0,0]
    v_cvt_pk_f16_f32 v80, v50, v51
    v_cvt_pk_f16_f32 v81, v52, v53
    buffer_load_dwordx4 v14, s[44:47], s23 offen offset:0 lds
    v_cvt_pk_f16_f32 v83, v54, v55
    v_cvt_pk_f16_f32 v87, v56, v57
    v_cvt_pk_f16_f32 v95, v58, v59
    ds_write_b32 v9, v72 offset:0
    v_pk_mul_f16 v107, v72, v73 op_sel:[0,0] op_sel_hi:[1,0]
    buffer_load_dwordx4 v15, s[44:47], s23 offen offset:1024 lds
    v_pk_fma_f16 v96, v72, v73, v107 op_sel:[1,1,0] op_sel_hi:[0,1,1] neg_lo:[1,0,0]
    v_pk_mul_f16 v108, v72, v76 op_sel:[0,0] op_sel_hi:[1,0]
    v_pk_fma_f16 v99, v72, v76, v108 op_sel:[1,1,0] op_sel_hi:[0,1,1] neg_lo:[1,0,0]
    ds_write_b32 v9, v96 offset:272
    v_pk_mul_f16 v107, v72, v74 op_sel:[0,0] op_sel_hi:[1,0]
    buffer_load_dwordx4 v16, s[44:47], s23 offen offset:2048 lds
    s_add_u32 m0, s66, 32768
    s_mul_i32 s23, s76, 1376
    v_pk_fma_f16 v97, v72, v74, v107 op_sel:[1,1,0] op_sel_hi:[0,1,1] neg_lo:[1,0,0]
    ds_write_b32 v9, v99 offset:2176
    v_pk_mul_f16 v108, v72, v77 op_sel:[0,0] op_sel_hi:[1,0]
    s_waitcnt vmcnt(10)
    s_waitcnt lgkmcnt(0)
    s_barrier
    s_setprio 1
    buffer_load_dwordx4 v10, s[36:39], s76 offen offset:0 lds
    v_pk_fma_f16 v101, v72, v77, v108 op_sel:[1,1,0] op_sel_hi:[0,1,1] neg_lo:[1,0,0]
    ds_write_b32 v9, v97 offset:544
    v_pk_mul_f16 v107, v96, v74 op_sel:[0,0] op_sel_hi:[1,0]
    v_pk_fma_f16 v98, v96, v74, v107 op_sel:[1,1,0] op_sel_hi:[0,1,1] neg_lo:[1,0,0]
    ds_write_b32 v9, v101 offset:3264
    buffer_load_dwordx4 v11, s[36:39], s76 offen offset:1024 lds
    v_pk_mul_f16 v108, v99, v74 op_sel:[0,0] op_sel_hi:[1,0]
    v_pk_fma_f16 v100, v99, v74, v108 op_sel:[1,1,0] op_sel_hi:[0,1,1] neg_lo:[1,0,0]
    ds_write_b32 v9, v98 offset:816
    v_pk_mul_f16 v107, v99, v77 op_sel:[0,0] op_sel_hi:[1,0]
    v_pk_fma_f16 v102, v99, v77, v107 op_sel:[1,1,0] op_sel_hi:[0,1,1] neg_lo:[1,0,0]
    buffer_load_dwordx4 v12, s[36:39], s76 offen offset:2048 lds
    ds_write_b32 v9, v100 offset:2448
    v_pk_mul_f16 v108, v72, v75 op_sel:[0,0] op_sel_hi:[1,0]
    v_pk_fma_f16 v103, v72, v75, v108 op_sel:[1,1,0] op_sel_hi:[0,1,1] neg_lo:[1,0,0]
    ds_write_b32 v9, v102 offset:3808
    v_pk_mul_f16 v107, v96, v75 op_sel:[0,0] op_sel_hi:[1,0]
    buffer_load_dwordx4 v13, s[36:39], s76 offen offset:3072 lds
    s_add_u32 m0, s67, 24576
    s_add_u32 s76, s76, 128
    s_and_b32 s76, s76, 0x3ff
    v_pk_fma_f16 v104, v96, v75, v107 op_sel:[1,1,0] op_sel_hi:[0,1,1] neg_lo:[1,0,0]
    ds_write_b32 v9, v103 offset:1088
    v_pk_mul_f16 v108, v97, v75 op_sel:[0,0] op_sel_hi:[1,0]
    v_pk_fma_f16 v105, v97, v75, v108 op_sel:[1,1,0] op_sel_hi:[0,1,1] neg_lo:[1,0,0]
    ds_write_b32 v9, v104 offset:1360
    buffer_load_dwordx4 v14, s[40:43], s23 offen offset:0 lds
    v_pk_mul_f16 v107, v98, v75 op_sel:[0,0] op_sel_hi:[1,0]
    v_pk_fma_f16 v106, v98, v75, v107 op_sel:[1,1,0] op_sel_hi:[0,1,1] neg_lo:[1,0,0]
    ds_write_b32 v9, v105 offset:1632
    v_pk_mul_f16 v108, v99, v75 op_sel:[0,0] op_sel_hi:[1,0]
    v_pk_fma_f16 v103, v99, v75, v108 op_sel:[1,1,0] op_sel_hi:[0,1,1] neg_lo:[1,0,0]
    buffer_load_dwordx4 v15, s[40:43], s23 offen offset:1024 lds
    ds_write_b32 v9, v106 offset:1904
    v_pk_mul_f16 v107, v100, v75 op_sel:[0,0] op_sel_hi:[1,0]
    v_pk_fma_f16 v104, v100, v75, v107 op_sel:[1,1,0] op_sel_hi:[0,1,1] neg_lo:[1,0,0]
    ds_write_b32 v9, v103 offset:2720
    v_pk_mul_f16 v108, v101, v75 op_sel:[0,0] op_sel_hi:[1,0]
    buffer_load_dwordx4 v16, s[40:43], s23 offen offset:2048 lds
    s_add_u32 m0, s68, 24576
    v_pk_fma_f16 v105, v101, v75, v108 op_sel:[1,1,0] op_sel_hi:[0,1,1] neg_lo:[1,0,0]
    ds_write_b32 v9, v104 offset:2992
    v_pk_mul_f16 v107, v102, v75 op_sel:[0,0] op_sel_hi:[1,0]
    v_pk_fma_f16 v106, v102, v75, v107 op_sel:[1,1,0] op_sel_hi:[0,1,1] neg_lo:[1,0,0]
    ds_write_b32 v9, v105 offset:3536
    buffer_load_dwordx4 v14, s[44:47], s23 offen offset:0 lds
    v_pk_mul_f16 v108, v72, v78 op_sel:[0,0] op_sel_hi:[1,0]
    v_pk_fma_f16 v103, v72, v78, v108 op_sel:[1,1,0] op_sel_hi:[0,1,1] neg_lo:[1,0,0]
    ds_write_b32 v9, v106 offset:4080
    v_pk_mul_f16 v107, v99, v78 op_sel:[0,0] op_sel_hi:[1,0]
    v_pk_fma_f16 v104, v99, v78, v107 op_sel:[1,1,0] op_sel_hi:[0,1,1] neg_lo:[1,0,0]
    buffer_load_dwordx4 v15, s[44:47], s23 offen offset:1024 lds
    ds_write_b32 v9, v103 offset:4352
    v_pk_mul_f16 v108, v101, v78 op_sel:[0,0] op_sel_hi:[1,0]
    v_pk_fma_f16 v105, v101, v78, v108 op_sel:[1,1,0] op_sel_hi:[0,1,1] neg_lo:[1,0,0]
    ds_write_b32 v9, v104 offset:4624
    buffer_load_dwordx4 v16, s[44:47], s23 offen offset:2048 lds
    s_add_u32 m0, s66, 0
    s_mul_i32 s23, s76, 1376
    s_waitcnt lgkmcnt(0)
    s_mul_i32 s60, s60, 0x9E3779B1
    s_add_u32 s60, s60, 0x7F4A7C15
    s_mov_b32 s61, s60
    s_waitcnt vmcnt(10)
    s_waitcnt lgkmcnt(0)
    s_barrier
    buffer_load_dwordx4 v10, s[36:39], s76 offen offset:0 lds
    v_pk_mul_f16 v107, v102, v78 op_sel:[0,0] op_sel_hi:[1,0]
    v_pk_fma_f16 v106, v102, v78, v107 op_sel:[1,1,0] op_sel_hi:[0,1,1] neg_lo:[1,0,0]
    ds_write_b32 v9, v105 offset:4896
    v_pk_mul_f16 v108, v72, v79 op_sel:[0,0] op_sel_hi:[1,0]
    v_pk_fma_f16 v103, v72, v79, v108 op_sel:[1,1,0] op_sel_hi:[0,1,1] neg_lo:[1,0,0]
    buffer_load_dwordx4 v11, s[36:39], s76 offen offset:1024 lds
    ds_write_b32 v9, v106 offset:5168
    ds_write_b32 v9, v103 offset:5440
    ds_read_b128 v[112:115], v109 offset:0
    ds_read_b128 v[116:119], v109 offset:32
    ds_read_b128 v[120:123], v109 offset:64
    buffer_load_dwordx4 v12, s[36:39], s76 offen offset:2048 lds
    ds_read_b128 v[124:127], v109 offset:96
    ds_read_b128 v[128:131], v109 offset:128
    ds_read_b128 v[132:135], v109 offset:160
    ds_read_b128 v[136:139], v109 offset:192
    ds_read_b128 v[140:143], v109 offset:224
    buffer_load_dwordx4 v13, s[36:39], s76 offen offset:3072 lds
    s_add_u32 m0, s67, 0
    s_add_u32 s76, s76, 128
    s_and_b32 s76, s76, 0x3ff
    v_mov_b32 v1, 0x3c00
    ds_write_b32 v9, v1 offset:0
    ds_write_b32 v9, v80 offset:272
    ds_write_b32 v9, v81 offset:544
    ds_write_b32 v9, v83 offset:1088
    buffer_load_dwordx4 v14, s[40:43], s23 offen offset:0 lds
    ds_write_b32 v9, v87 offset:2176
    ds_write_b32 v9, v95 offset:4352
    v_pk_mul_f16 v107, v80, v81 op_sel:[0,0] op_sel_hi:[1,0]
    v_pk_fma_f16 v82, v80, v81, v107 op_sel:[1,1,0] op_sel_hi:[0,1,1] neg_lo:[1,0,0]
    v_pk_mul_f16 v108, v80, v83 op_sel:[0,0] op_sel_hi:[1,0]
    buffer_load_dwordx4 v15, s[40:43], s23 offen offset:1024 lds
    v_pk_fma_f16 v84, v80, v83, v108 op_sel:[1,1,0] op_sel_hi:[0,1,1] neg_lo:[1,0,0]
    ds_write_b32 v9, v82 offset:816
    v_pk_mul_f16 v107, v81, v83 op_sel:[0,0] op_sel_hi:[1,0]
    v_pk_fma_f16 v85, v81, v83, v107 op_sel:[1,1,0] op_sel_hi:[0,1,1] neg_lo:[1,0,0]
    ds_write_b32 v9, v84 offset:1360
    buffer_load_dwordx4 v16, s[40:43], s23 offen offset:2048 lds
    s_add_u32 m0, s68, 0
    v_pk_mul_f16 v108, v82, v83 op_sel:[0,0] op_sel_hi:[1,0]
    v_pk_fma_f16 v86, v82, v83, v108 op_sel:[1,1,0] op_sel_hi:[0,1,1] neg_lo:[1,0,0]
    ds_write_b32 v9, v85 offset:1632
    v_pk_mul_f16 v107, v80, v87 op_sel:[0,0] op_sel_hi:[1,0]
    v_pk_fma_f16 v88, v80, v87, v107 op_sel:[1,1,0] op_sel_hi:[0,1,1] neg_lo:[1,0,0]
    buffer_load_dwordx4 v14, s[44:47], s23 offen offset:0 lds
    ds_write_b32 v9, v86 offset:1904
    v_pk_mul_f16 v108, v81, v87 op_sel:[0,0] op_sel_hi:[1,0]
    v_pk_fma_f16 v89, v81, v87, v108 op_sel:[1,1,0] op_sel_hi:[0,1,1] neg_lo:[1,0,0]
    ds_write_b32 v9, v88 offset:2448
    v_pk_mul_f16 v107, v82, v87 op_sel:[0,0] op_sel_hi:[1,0]
    buffer_load_dwordx4 v15, s[44:47], s23 offen offset:1024 lds
    v_pk_fma_f16 v90, v82, v87, v107 op_sel:[1,1,0] op_sel_hi:[0,1,1] neg_lo:[1,0,0]
    ds_write_b32 v9, v89 offset:2720
    v_pk_mul_f16 v108, v83, v87 op_sel:[0,0] op_sel_hi:[1,0]
    v_pk_fma_f16 v91, v83, v87, v108 op_sel:[1,1,0] op_sel_hi:[0,1,1] neg_lo:[1,0,0]
    buffer_load_dwordx4 v16, s[44:47], s23 offen offset:2048 lds
    s_add_u32 m0, s66, 16384
    s_mul_i32 s23, s76, 1376
    s_waitcnt vmcnt(10)
    s_waitcnt lgkmcnt(0)
    s_barrier
    v_mov_b32 v248, s60
    v_mul_u32_u24 v249, 4352, v0
    s_bfm_b64 exec, 32, 0
    buffer_store_dword v248, v249, s[56:59], s31 offen sc1
    s_mov_b64 exec, -1
    s_lshr_b32 s31, s2, 3
    s_lshl_b32 s31, s31, 2
    s_add_u32 s31, s31, s74
    s_lshl_b32 s31, s31, 3
    s_and_b32 s78, s2, 7
    s_add_u32 s31, s31, s78
    s_and_b32 s31, s31, 31
    s_mul_i32 s31, s31, 4352
    s_add_u32 s31, s31, 11010048
    ds_write_b32 v9, v90 offset:2992
    v_pk_mul_f16 v107, v84, v87 op_sel:[0,0] op_sel_hi:[1,0]
    v_pk_fma_f16 v92, v84, v87, v107 op_sel:[1,1,0] op_sel_hi:[0,1,1] neg_lo:[1,0,0]
    ds_write_b32 v9, v91 offset:3264
    buffer_load_dwordx4 v10, s[36:39], s76 offen offset:0 lds
    v_pk_mul_f16 v108, v85, v87 op_sel:[0,0] op_sel_hi:[1,0]
    v_pk_fma_f16 v93, v85, v87, v108 op_sel:[1,1,0] op_sel_hi:[0,1,1] neg_lo:[1,0,0]
    ds_write_b32 v9, v92 offset:3536
    v_pk_mul_f16 v107, v86, v87 op_sel:[0,0] op_sel_hi:[1,0]
    buffer_load_dwordx4 v11, s[36:39], s76 offen offset:1024 lds
    v_pk_fma_f16 v94, v86, v87, v107 op_sel:[1,1,0] op_sel_hi:[0,1,1] neg_lo:[1,0,0]
    ds_write_b32 v9, v93 offset:3808
    v_pk_mul_f16 v108, v80, v95 op_sel:[0,0] op_sel_hi:[1,0]
    v_pk_fma_f16 v104, v80, v95, v108 op_sel:[1,1,0] op_sel_hi:[0,1,1] neg_lo:[1,0,0]
    buffer_load_dwordx4 v12, s[36:39], s76 offen offset:2048 lds
    ds_write_b32 v9, v94 offset:4080
    v_pk_mul_f16 v107, v81, v95 op_sel:[0,0] op_sel_hi:[1,0]
    v_pk_fma_f16 v105, v81, v95, v107 op_sel:[1,1,0] op_sel_hi:[0,1,1] neg_lo:[1,0,0]
    ds_write_b32 v9, v104 offset:4624
    buffer_load_dwordx4 v13, s[36:39], s76 offen offset:3072 lds
    s_add_u32 m0, s67, 12288
    s_add_u32 s76, s76, 128
    s_and_b32 s76, s76, 0x3ff
    v_pk_mul_f16 v108, v82, v95 op_sel:[0,0] op_sel_hi:[1,0]
    v_pk_fma_f16 v106, v82, v95, v108 op_sel:[1,1,0] op_sel_hi:[0,1,1] neg_lo:[1,0,0]
    ds_write_b32 v9, v105 offset:4896
    v_pk_mul_f16 v107, v83, v95 op_sel:[0,0] op_sel_hi:[1,0]
    buffer_load_dwordx4 v14, s[40:43], s23 offen offset:0 lds
    v_pk_fma_f16 v103, v83, v95, v107 op_sel:[1,1,0] op_sel_hi:[0,1,1] neg_lo:[1,0,0]
    ds_write_b32 v9, v106 offset:5168
    v_pk_mul_f16 v108, v84, v95 op_sel:[0,0] op_sel_hi:[1,0]
    v_pk_fma_f16 v104, v84, v95, v108 op_sel:[1,1,0] op_sel_hi:[0,1,1] neg_lo:[1,0,0]
    buffer_load_dwordx4 v15, s[40:43], s23 offen offset:1024 lds
    ds_write_b32 v9, v103 offset:5440
    v_pk_mul_f16 v107, v85, v95 op_sel:[0,0] op_sel_hi:[1,0]
    v_pk_fma_f16 v105, v85, v95, v107 op_sel:[1,1,0] op_sel_hi:[0,1,1] neg_lo:[1,0,0]
    ds_write_b32 v9, v104 offset:5712
    buffer_load_dwordx4 v16, s[40:43], s23 offen offset:2048 lds
    s_add_u32 m0, s68, 12288
    v_pk_mul_f16 v108, v86, v95 op_sel:[0,0] op_sel_hi:[1,0]
    v_pk_fma_f16 v106, v86, v95, v108 op_sel:[1,1,0] op_sel_hi:[0,1,1] neg_lo:[1,0,0]
    ds_write_b32 v9, v105 offset:5984
    v_pk_mul_f16 v107, v87, v95 op_sel:[0,0] op_sel_hi:[1,0]
    buffer_load_dwordx4 v14, s[44:47], s23 offen offset:0 lds
    v_pk_fma_f16 v103, v87, v95, v107 op_sel:[1,1,0] op_sel_hi:[0,1,1] neg_lo:[1,0,0]
    ds_write_b32 v9, v106 offset:6256
    v_pk_mul_f16 v108, v88, v95 op_sel:[0,0] op_sel_hi:[1,0]
    v_pk_fma_f16 v104, v88, v95, v108 op_sel:[1,1,0] op_sel_hi:[0,1,1] neg_lo:[1,0,0]
    buffer_load_dwordx4 v15, s[44:47], s23 offen offset:1024 lds
    buffer_load_dwordx4 v16, s[44:47], s23 offen offset:2048 lds
    s_add_u32 m0, s66, 32768
    s_mul_i32 s23, s76, 1376
    s_waitcnt vmcnt(11)
    s_waitcnt lgkmcnt(0)
    s_barrier
    buffer_load_dwordx4 v10, s[36:39], s76 offen offset:0 lds
    ds_write_b32 v9, v103 offset:6528
    v_pk_mul_f16 v107, v89, v95 op_sel:[0,0] op_sel_hi:[1,0]
    v_pk_fma_f16 v105, v89, v95, v107 op_sel:[1,1,0] op_sel_hi:[0,1,1] neg_lo:[1,0,0]
    ds_write_b32 v9, v104 offset:6800
    buffer_load_dwordx4 v11, s[36:39], s76 offen offset:1024 lds
    v_pk_mul_f16 v108, v90, v95 op_sel:[0,0] op_sel_hi:[1,0]
    v_pk_fma_f16 v106, v90, v95, v108 op_sel:[1,1,0] op_sel_hi:[0,1,1] neg_lo:[1,0,0]
    ds_write_b32 v9, v105 offset:7072
    v_pk_mul_f16 v107, v91, v95 op_sel:[0,0] op_sel_hi:[1,0]
    buffer_load_dwordx4 v12, s[36:39], s76 offen offset:2048 lds
    v_pk_fma_f16 v103, v91, v95, v107 op_sel:[1,1,0] op_sel_hi:[0,1,1] neg_lo:[1,0,0]
    ds_write_b32 v9, v106 offset:7344
    v_pk_mul_f16 v108, v92, v95 op_sel:[0,0] op_sel_hi:[1,0]
    v_pk_fma_f16 v104, v92, v95, v108 op_sel:[1,1,0] op_sel_hi:[0,1,1] neg_lo:[1,0,0]
    buffer_load_dwordx4 v13, s[36:39], s76 offen offset:3072 lds
    s_add_u32 m0, s67, 24576
    s_add_u32 s76, s76, 128
    s_and_b32 s76, s76, 0x3ff
    ds_write_b32 v9, v103 offset:7616
    v_pk_mul_f16 v107, v93, v95 op_sel:[0,0] op_sel_hi:[1,0]
    v_pk_fma_f16 v105, v93, v95, v107 op_sel:[1,1,0] op_sel_hi:[0,1,1] neg_lo:[1,0,0]
    ds_write_b32 v9, v104 offset:7888
    buffer_load_dwordx4 v14, s[40:43], s23 offen offset:0 lds
    v_lshrrev_b32 v3, 3, v0
    v_and_b32 v8, 7, v0
    v_bfe_u32 v18, v0, 4, 1
    v_lshlrev_b32 v18, 2, v18
    buffer_load_dwordx4 v15, s[40:43], s23 offen offset:1024 lds
    v_xor_b32 v8, v8, v18
    v_lshlrev_b32 v8, 4, v8
    v_lshl_add_u32 v17, v3, 10, v8
    v_and_b32 v3, 31, v0
    buffer_load_dwordx4 v16, s[40:43], s23 offen offset:2048 lds
    s_add_u32 m0, s68, 24576
    v_lshrrev_b32 v8, 5, v0
    v_lshlrev_b32 v8, 4, v8
    v_lshl_add_u32 v239, v3, 7, v8
    s_and_b32 s101, s100, 0
    s_mul_i32 s101, s101, 688
    s_bfe_u32 s72, s2, 0x20003
    s_mul_i32 s72, s72, 0
    s_add_u32 s101, s101, s72
    s_and_b32 s72, s2, 7
    s_mul_i32 s72, s72, 0
    s_add_u32 s101, s101, s72
    s_lshr_b32 s101, s101, 4
    s_cmp_ge_u32 s101, 43
    s_cselect_b32 s72, 43, 0
    s_sub_u32 s101, s101, s72
    buffer_load_dwordx4 v14, s[44:47], s23 offen offset:0 lds
    s_lshl_b32 s6, s74, 12
    s_mul_i32 s7, s74, 3072
    s_lshl_b32 s8, s74, 10
    s_mul_i32 s10, s75, 704512
    s_lshl_b32 s72, s77, 13
    s_add_u32 s10, s10, s72
    s_lshl_b32 s72, s100, 7
    s_add_u32 s10, s10, s72
    s_add_u32 s11, s10, 704512
    s_lshl_b32 s72, s101, 14
    s_add_u32 s9, s10, s72
    v_pk_mul_f16 v108, v94, v95 op_sel:[0,0] op_sel_hi:[1,0]
    v_pk_fma_f16 v106, v94, v95, v108 op_sel:[1,1,0] op_sel_hi:[0,1,1] neg_lo:[1,0,0]
    ds_write_b32 v9, v105 offset:8160
    buffer_load_dwordx4 v15, s[44:47], s23 offen offset:1024 lds
    ds_write_b32 v9, v106 offset:8432
    ds_read_b128 v[144:147], v109 offset:0
    ds_read_b128 v[148:151], v109 offset:32
    ds_read_b128 v[152:155], v109 offset:64
    buffer_load_dwordx4 v16, s[44:47], s23 offen offset:2048 lds
    s_add_u32 m0, s66, 0
    s_mul_i32 s23, s76, 1376
    ds_read_b128 v[156:159], v109 offset:96
    ds_read_b128 v[160:163], v109 offset:128
    s_waitcnt vmcnt(10)
    s_waitcnt lgkmcnt(0)
    s_barrier
    buffer_load_dwordx4 v10, s[36:39], s76 offen offset:0 lds
    ds_read_b128 v[164:167], v109 offset:160
    ds_read_b128 v[168:171], v109 offset:192
    ds_read_b128 v[172:175], v109 offset:224
    buffer_load_dwordx4 v11, s[36:39], s76 offen offset:1024 lds
    v_mfma_f32_32x32x16_f16 v[176:191], v[112:115], v[144:147], 0
    v_and_b32 v1, 31, v0
    v_lshrrev_b32 v2, 5, v0
    buffer_load_dwordx4 v12, s[36:39], s76 offen offset:2048 lds
    s_xor_b32 s24, s74, 1
    s_mul_i32 s24, s24, 8704
    s_add_u32 s24, s24, 0
    v_add_u32 v111, s24, v31
    s_mul_i32 s17, s75, 2704
    s_add_u32 s17, s17, 157776
    s_mul_i32 s18, s77, 62
    s_add_u32 s18, s18, 128
    s_lshl_b32 s19, s77, 3
    s_add_u32 s19, s19, s17
    s_add_u32 s19, s19, 1024
    buffer_load_dwordx4 v13, s[36:39], s76 offen offset:3072 lds
    s_add_u32 m0, s67, 0
    s_add_u32 s76, s76, 128
    s_and_b32 s76, s76, 0x3ff
    v_mfma_f32_32x32x16_f16 v[176:191], v[116:119], v[148:151], v[176:191]
    v_sub_u32 v8, 2, v2
    v_lshlrev_b32 v3, v8, v1
    buffer_load_dwordx4 v14, s[40:43], s23 offen offset:0 lds
    v_mad_u32_u24 v3, v2, s18, v3
    v_lshl_add_u32 v224, v3, 2, s19
    v_mfma_f32_32x32x16_f16 v[176:191], v[120:123], v[152:155], v[176:191]
    buffer_load_dwordx4 v15, s[40:43], s23 offen offset:1024 lds
    s_mul_i32 s18, s77, 124
    s_add_u32 s18, s18, 4
    s_lshl_b32 s19, s77, 11
    s_add_u32 s19, s19, s17
    s_mul_i32 s20, s77, 3
    s_sub_u32 s20, 3, s20
    v_lshlrev_b32 v3, s20, v1
    v_mad_u32_u24 v3, v2, s18, v3
    buffer_load_dwordx4 v16, s[40:43], s23 offen offset:2048 lds
    s_add_u32 m0, s68, 0
    v_lshl_add_u32 v225, v3, 2, s19
    v_mfma_f32_32x32x16_f16 v[176:191], v[124:127], v[156:159], v[176:191]
    v_lshrrev_b32 v1, 4, v0
    buffer_load_dwordx4 v14, s[44:47], s23 offen offset:0 lds
    v_and_b32 v2, 15, v0
    v_bfe_u32 v3, v0, 2, 2
    v_and_b32 v8, 3, v0
    buffer_load_dwordx4 v15, s[44:47], s23 offen offset:1024 lds
    v_mfma_f32_32x32x16_f16 v[176:191], v[128:131], v[160:163], v[176:191]
    v_mul_u32_u24 v3, 4160, v3
    buffer_load_dwordx4 v16, s[44:47], s23 offen offset:2048 lds
    s_add_u32 m0, s66, 16384
    s_mul_i32 s23, s76, 1376
    s_waitcnt vmcnt(10)
    s_waitcnt lgkmcnt(0)
    s_barrier
    buffer_load_dwordx4 v[240:243], v31, s[56:59], s31 offen sc1
    buffer_load_dwordx4 v10, s[36:39], s76 offen offset:0 lds
    v_lshl_add_u32 v3, v8, 3, v3
    v_mad_i32_i24 v3, v1, -16, v3
    s_mul_i32 s21, s75, 17408
    s_add_u32 s21, s21, 0
    s_lshl_b32 s72, s77, 8
    s_add_u32 s72, s72, s21
    s_add_u32 s72, s72, 56
    buffer_load_dwordx4 v11, s[36:39], s76 offen offset:1024 lds
    v_mfma_f32_32x32x16_f16 v[176:191], v[132:135], v[164:167], v[176:191]
    v_add_u32 v228, s72, v3
    v_add_u32 v233, s21, v31
    buffer_load_dwordx4 v12, s[36:39], s76 offen offset:2048 lds
    v_lshl_add_u32 v3, v2, 1, v1
    s_lshl_b32 s72, s77, 4
    s_sub_u32 s72, 30, s72
    s_lshl_b32 s28, s75, 9
    s_add_u32 s28, s28, 111616
    v_mfma_f32_32x32x16_f16 v[176:191], v[136:139], v[168:171], v[176:191]
    buffer_load_dwordx4 v13, s[36:39], s76 offen offset:3072 lds
    s_add_u32 m0, s67, 12288
    v_add_u32 v232, s72, v3
    v_and_b32 v8, 32, v232
    v_add_u32 v8, v8, v232
    buffer_load_dwordx4 v14, s[40:43], s23 offen offset:0 lds
    v_lshl_add_u32 v229, v8, 4, s28
    v_mfma_f32_32x32x16_f16 v[176:191], v[140:143], v[172:175], v[176:191]
    v_subrev_u32 v232, 4, v232
    buffer_load_dwordx4 v15, s[40:43], s23 offen offset:1024 lds
    v_and_b32 v8, 32, v232
    v_add_u32 v8, v8, v232
    v_lshl_add_u32 v230, v8, 4, s28
    buffer_load_dwordx4 v16, s[40:43], s23 offen offset:2048 lds
    s_add_u32 m0, s68, 12288
    s_cmp_eq_u32 s77, 0
    s_cbranch_scc0 HF_25
    s_sub_u32 s18, s17, 12
    s_add_u32 s19, s18, 512
    v_lshl_add_u32 v1, v0, 5, s18
    v_lshl_add_u32 v2, v0, 4, s19
    v_min_u32 v21, v1, v2
    v_lshrrev_b32 v1, 5, v0
    v_add_u32 v2, 31, v0
    v_mad_i32_i24 v22, v1, -4, v21
    v_lshrrev_b32 v2, 6, v2
    v_mad_i32_i24 v23, v1, -8, v21
    v_lshl_add_u32 v20, v2, 2, v21
    v_mad_i32_i24 v24, v1, -12, v21
    v_lshrrev_b32 v1, 1, v0
    v_mul_u32_u24 v1, 4128, v1
    v_add_u32 v25, v1, v233
    v_mov_b64 v[4:5], 0
    v_mov_b64 v[6:7], 0
    v_mul_f32 v80, s27, v182
    v_mul_f32 v81, s27, v183
    v_mul_f32 v82, s27, v184
    v_mul_f32 v83, s27, v185
    v_mul_f32 v84, s27, v186
    v_mul_f32 v85, s27, v187
    ds_write_b128 v110, v[80:83]
    ds_write_b64 v110, v[84:85] offset:1024
    s_branch HFX_26
HF_25:
    s_add_u32 s18, s17, 1528
    s_add_u32 s19, s17, 2044
    v_min_u32 v1, 1, v0
    v_lshl_add_u32 v20, v0, 3, s18
    v_lshl_add_u32 v22, v0, 2, s19
    v_and_b32 v2, 1, v0
    v_lshl_add_u32 v21, v1, 2, v20
    v_lshl_add_u32 v24, v1, 2, v22
    v_lshl_add_u32 v23, v2, 2, v22
    v_mul_f32 v80, s27, v176
    v_mul_f32 v81, s27, v177
    v_mul_f32 v82, s27, v178
    v_mul_f32 v83, s27, v179
    v_mul_f32 v84, s27, v180
    v_mul_f32 v85, s27, v181
    ds_write_b128 v110, v[80:83]
    ds_write_b64 v110, v[84:85] offset:1024
HFX_26:
    buffer_load_dwordx4 v14, s[44:47], s23 offen offset:0 lds
    buffer_load_dwordx4 v15, s[44:47], s23 offen offset:1024 lds
    buffer_load_dwordx4 v16, s[44:47], s23 offen offset:2048 lds
    s_waitcnt vmcnt(11)
    s_waitcnt lgkmcnt(0)
    s_barrier
    s_waitcnt vmcnt(10)
    v_xor_b32 v240, s60, v240
    v_xor_b32 v241, s60, v241
    v_xor_b32 v242, s60, v242
    v_xor_b32 v243, s60, v243
    v_or3_b32 v240, v240, v241, v242
    v_or_b32 v240, v240, v243
    v_cmp_ne_u32 vcc, 0, v240
    s_cmp_eq_u64 vcc, 0
    s_cbranch_scc1 FAX_27
    s_mov_b32 s79, 65536
FA_28:
    buffer_load_dwordx4 v[240:243], v31, s[56:59], s31 offen sc1
    s_waitcnt vmcnt(0)
    v_xor_b32 v240, s60, v240
    v_xor_b32 v241, s60, v241
    v_xor_b32 v242, s60, v242
    v_xor_b32 v243, s60, v243
    v_or3_b32 v240, v240, v241, v242
    v_or_b32 v240, v240, v243
    v_cmp_ne_u32 vcc, 0, v240
    s_cmp_eq_u64 vcc, 0
    s_cbranch_scc1 FAX_27
    s_sub_u32 s79, s79, 1
    s_cmp_lg_u32 s79, 0
    s_cbranch_scc1 FA_28
FAX_27:
    s_mul_i32 s15, s63, 6144
    s_add_u32 s15, s15, s8
    s_add_u32 s15, s15, 32768
    s_add_u32 s16, s8, 108544
    s_cmp_lt_u32 s74, 3
    s_cselect_b32 m0, s16, 145440
    s_add_u32 s16, s15, 4096
    buffer_load_dwordx4 v31, s[56:59], s15 offen sc1 lds
    s_lshl_b32 s15, s62, 10
    s_add_u32 s15, s15, 4096
    s_cmp_lt_u32 s74, 2
    s_cselect_b32 s15, s16, s15
    s_min_u32 s16, s8, 2048
    s_add_u32 m0, s16, 146464
    s_nop 0
    buffer_load_dwordx4 v31, s[56:59], s15 offen sc1 lds
    s_or_b32 s15, s2, s74
    s_cmp_eq_u32 s15, 0
    s_cbranch_scc0 EP_29
    v_mov_b32 v194, s60
    v_mov_b32 v195, 0
    s_mov_b64 exec, 1
    buffer_store_dword v194, v195, s[56:59], 0 offen sc1
    s_mov_b64 exec, -1
EP_29:
    s_lshr_b32 s13, s2, 5
    s_lshl_b32 s13, s13, 3
    s_and_b32 s14, s2, 7
    s_add_u32 s13, s13, s14
    s_lshl_b32 s13, s13, 15
    s_bfe_u32 s14, s2, 131075
    s_lshl_b32 s14, s14, 5
    s_add_u32 s13, s13, s14
    s_lshl_b32 s14, s74, 13
    s_add_u32 s13, s13, s14
    s_lshl_b32 s14, s74, 11
    s_add_u32 s13, s13, 262144
    s_add_u32 m0, s14, 112640
    s_nop 0
    buffer_load_dwordx4 v239, s[56:59], s13 offen offset:0 sc1 lds
    s_lshr_b32 s15, s8, 2
    s_add_u32 s15, s15, 111616
    v_add_u32 v192, s15, v31
    v_mov_b64 v[196:197], 0
    s_add_u32 s13, s13, 3072
    buffer_load_dwordx4 v239, s[56:59], s13 offen offset:1024 sc1 lds
    v_mov_b64 v[198:199], 0
    s_mov_b64 exec, 0xffff
    ds_write_b128 v192, v[196:199]
    s_mov_b64 exec, -1
    s_add_u32 m0, s6, 67584
    s_nop 0
    buffer_load_dwordx4 v17, s[48:51], s9 offen lds
    s_add_u32 s9, s9, 16384
    s_cmp_eq_u32 s9, s11
    s_cselect_b32 s9, s10, s9
    s_add_u32 m0, s6, 68608
    s_nop 0
    buffer_load_dwordx4 v17, s[48:51], s9 offen lds
    s_add_u32 s9, s9, 16384
    s_cmp_eq_u32 s9, s11
    s_cselect_b32 s9, s10, s9
    ds_read_b128 v[80:83], v111
    ds_read_b64 v[84:85], v111 offset:1024
    s_add_u32 m0, s6, 69632
    s_nop 0
    buffer_load_dwordx4 v17, s[48:51], s9 offen lds
    s_add_u32 s9, s9, 16384
    s_cmp_eq_u32 s9, s11
    s_cselect_b32 s9, s10, s9
    s_cmp_eq_u32 s77, 0
    s_cbranch_scc0 HF_30
    s_waitcnt lgkmcnt(1)
    v_fma_f32 v80, v176, s27, v80
    v_fma_f32 v81, v177, s27, v81
    v_fma_f32 v82, v178, s27, v82
    v_fma_f32 v83, v179, s27, v83
    s_waitcnt lgkmcnt(0)
    v_fma_f32 v84, v180, s27, v84
    v_fma_f32 v85, v181, s27, v85
    s_mov_b64 exec, 1
    v_add_f32 v80, v80, v39
    s_mov_b64 exec, -1
    ds_write_b128 v225, v[80:83]
    ds_write_b64 v224, v[84:85]
    s_branch HFX_31
HF_30:
    s_waitcnt lgkmcnt(1)
    v_fma_f32 v80, v182, s27, v80
    v_fma_f32 v81, v183, s27, v81
    v_fma_f32 v82, v184, s27, v82
    v_fma_f32 v83, v185, s27, v83
    s_waitcnt lgkmcnt(0)
    v_fma_f32 v84, v186, s27, v84
    v_fma_f32 v85, v187, s27, v85
    ds_write_b64 v224, v[80:81]
    ds_write_b32 v225, v82
    s_mov_b32 exec_hi, 0
    ds_write2_b32 v225, v83, v84 offset0:32 offset1:64
    ds_write_b32 v225, v85 offset:384
    s_mov_b64 exec, -1
HFX_31:
    s_add_u32 m0, s6, 70656
    s_nop 0
    buffer_load_dwordx4 v17, s[48:51], s9 offen lds
    s_add_u32 s9, s9, 16384
    s_cmp_eq_u32 s9, s11
    s_cselect_b32 s9, s10, s9
    s_add_u32 m0, s8, 149536
    s_nop 0
    buffer_load_dwordx4 v17, s[48:51], s9 offen lds
    s_add_u32 s9, s9, 16384
    s_cmp_eq_u32 s9, s11
    s_cselect_b32 s9, s10, s9
    s_add_u32 m0, s8, 153632
    s_nop 0
    buffer_load_dwordx4 v17, s[48:51], s9 offen lds
    s_add_u32 s9, s9, 16384
    s_cmp_eq_u32 s9, s11
    s_cselect_b32 s9, s10, s9
    s_waitcnt vmcnt(10)
    s_waitcnt lgkmcnt(0)
    s_barrier
    s_add_u32 m0, s6, 34816
    s_nop 0
    buffer_load_dwordx4 v17, s[48:51], s9 offen lds
    s_add_u32 s9, s9, 16384
    s_cmp_eq_u32 s9, s11
    s_cselect_b32 s9, s10, s9
    s_waitcnt vmcnt(9)
    s_mov_b64 exec, 1
    ds_add_u32 v244, v245 offset:52
    s_mov_b64 exec, -1
    s_add_u32 m0, s6, 35840
    s_nop 0
    buffer_load_dwordx4 v17, s[48:51], s9 offen lds
    s_add_u32 s9, s9, 16384
    s_cmp_eq_u32 s9, s11
    s_cselect_b32 s9, s10, s9
    s_add_u32 m0, s6, 36864
    s_nop 0
    buffer_load_dwordx4 v17, s[48:51], s9 offen lds
    s_add_u32 s9, s9, 16384
    s_cmp_eq_u32 s9, s11
    s_cselect_b32 s9, s10, s9
    s_add_u32 m0, s6, 37888
    s_nop 0
    buffer_load_dwordx4 v17, s[48:51], s9 offen lds
    s_add_u32 s9, s9, 16384
    s_cmp_eq_u32 s9, s11
    s_cselect_b32 s9, s10, s9
    s_add_u32 m0, s7, 83968
    s_nop 0
    buffer_load_dwordx4 v17, s[48:51], s9 offen lds
    s_add_u32 s9, s9, 16384
    s_cmp_eq_u32 s9, s11
    s_cselect_b32 s9, s10, s9
    s_add_u32 m0, s7, 84992
    s_nop 0
    buffer_load_dwordx4 v17, s[48:51], s9 offen lds
    s_add_u32 s9, s9, 16384
    s_cmp_eq_u32 s9, s11
    s_cselect_b32 s9, s10, s9
    s_add_u32 m0, s7, 86016
    s_nop 0
    buffer_load_dwordx4 v17, s[48:51], s9 offen lds
    s_add_u32 s9, s9, 16384
    s_cmp_eq_u32 s9, s11
    s_cselect_b32 s9, s10, s9
    s_add_u32 m0, s7, 120864
    s_nop 0
    buffer_load_dwordx4 v17, s[48:51], s9 offen lds
    s_add_u32 s9, s9, 16384
    s_cmp_eq_u32 s9, s11
    s_cselect_b32 s9, s10, s9
    s_add_u32 m0, s7, 121888
    s_nop 0
    buffer_load_dwordx4 v17, s[48:51], s9 offen lds
    s_add_u32 s9, s9, 16384
    s_cmp_eq_u32 s9, s11
    s_cselect_b32 s9, s10, s9
    s_add_u32 m0, s7, 122912
    s_nop 0
    buffer_load_dwordx4 v17, s[48:51], s9 offen lds
    s_add_u32 s9, s9, 16384
    s_cmp_eq_u32 s9, s11
    s_cselect_b32 s9, s10, s9
    s_cmp_eq_u32 s77, 0
    s_cbranch_scc0 HF_32
    ds_read2_b32 v[80:81], v20 offset0:0 offset1:1
    ds_read_b32 v82, v20 offset:8
    ds_read_b32 v83, v21 offset:12
    ds_read2_b32 v[84:85], v22 offset0:4 offset1:5
    ds_read_b32 v86, v22 offset:24
    ds_read_b32 v87, v23 offset:28
    ds_read2_b32 v[88:89], v24 offset0:8 offset1:9
    ds_read_b32 v90, v24 offset:40
    s_mov_b64 exec, 0xff
    ds_write_b128 v25, v[4:7]
    s_mov_b64 exec, -1
    s_waitcnt lgkmcnt(8)
    v_cvt_pk_bf16_f32 v116, v80, v81
    s_waitcnt lgkmcnt(6)
    v_cvt_pk_bf16_f32 v117, v82, v83
    s_waitcnt lgkmcnt(5)
    v_cvt_pk_bf16_f32 v118, v84, v85
    s_waitcnt lgkmcnt(3)
    v_cvt_pk_bf16_f32 v119, v86, v87
    ds_write_b128 v233, v[116:119] offset:12512
    v_cvt_pk_bf16_f32 v112, v81, v82
    v_cvt_pk_bf16_f32 v113, v83, v84
    v_cvt_pk_bf16_f32 v114, v85, v86
    s_waitcnt lgkmcnt(3)
    v_cvt_pk_bf16_f32 v115, v87, v88
    ds_write_b128 v233, v[112:115] offset:8352
    v_cvt_pk_bf16_f32 v108, v82, v83
    v_cvt_pk_bf16_f32 v109, v84, v85
    v_cvt_pk_bf16_f32 v110, v86, v87
    v_cvt_pk_bf16_f32 v111, v88, v89
    ds_write_b128 v233, v[108:111] offset:4192
    v_cvt_pk_bf16_f32 v104, v83, v84
    v_cvt_pk_bf16_f32 v105, v85, v86
    v_cvt_pk_bf16_f32 v106, v87, v88
    s_waitcnt lgkmcnt(4)
    v_cvt_pk_bf16_f32 v107, v89, v90
    ds_write_b128 v233, v[104:107] offset:32
    s_branch HFX_33
HF_32:
    ds_read2_b32 v[82:83], v20 offset0:2 offset1:3
    ds_read_b32 v84, v20 offset:16
    ds_read2_b32 v[86:87], v22 offset0:1 offset1:2
    ds_read_b32 v88, v23 offset:4
    ds_read2_b32 v[80:81], v21 offset0:0 offset1:1
    ds_read_b32 v89, v24
    ds_read2_b32 v[90:91], v22 offset0:65 offset1:66
    ds_read_b32 v92, v23 offset:260
    s_waitcnt lgkmcnt(7)
    v_cvt_pk_bf16_f32 v104, v82, v82
    v_cvt_pk_bf16_f32 v105, v82, v83
    v_cvt_pk_bf16_f32 v106, v83, v83
    s_waitcnt lgkmcnt(6)
    v_cvt_pk_bf16_f32 v107, v84, v84
    ds_write_b128 v233, v[104:107] offset:1056
    s_waitcnt lgkmcnt(6)
    v_cvt_pk_bf16_f32 v108, v86, v86
    v_cvt_pk_bf16_f32 v109, v86, v86
    s_waitcnt lgkmcnt(5)
    v_cvt_pk_bf16_f32 v110, v88, v87
    v_cvt_pk_bf16_f32 v111, v87, v87
    ds_write_b128 v233, v[108:111] offset:2080
    s_waitcnt lgkmcnt(3)
    v_cvt_pk_bf16_f32 v112, v90, v90
    v_cvt_pk_bf16_f32 v113, v90, v90
    s_waitcnt lgkmcnt(2)
    v_cvt_pk_bf16_f32 v114, v92, v91
    v_cvt_pk_bf16_f32 v115, v91, v91
    ds_write_b128 v233, v[112:115] offset:3104
    v_cvt_pk_bf16_f32 v105, v82, v82
    v_cvt_pk_bf16_f32 v107, v83, v84
    ds_write_b128 v233, v[104:107] offset:5216
    v_cvt_pk_bf16_f32 v110, v86, v88
    ds_write_b128 v233, v[108:111] offset:6240
    v_cvt_pk_bf16_f32 v114, v90, v92
    ds_write_b128 v233, v[112:115] offset:7264
    v_cvt_pk_bf16_f32 v104, v81, v82
    v_cvt_pk_bf16_f32 v106, v82, v83
    v_cvt_pk_bf16_f32 v107, v83, v83
    ds_write_b128 v233, v[104:107] offset:9376
    v_cvt_pk_bf16_f32 v110, v86, v86
    v_cvt_pk_bf16_f32 v111, v88, v87
    ds_write_b128 v233, v[108:111] offset:10400
    v_cvt_pk_bf16_f32 v114, v90, v90
    v_cvt_pk_bf16_f32 v115, v92, v91
    ds_write_b128 v233, v[112:115] offset:11424
    v_cvt_pk_bf16_f32 v104, v80, v81
    v_cvt_pk_bf16_f32 v106, v82, v82
    ds_write_b128 v233, v[104:107] offset:13536
    v_cvt_pk_bf16_f32 v108, v89, v86
    v_cvt_pk_bf16_f32 v111, v86, v88
    ds_write_b128 v233, v[108:111] offset:14560
    v_cvt_pk_bf16_f32 v115, v90, v92
    ds_write_b128 v233, v[112:115] offset:15584
HFX_33:
    s_waitcnt vmcnt(16)
    s_mov_b64 exec, 1
    ds_add_u32 v244, v245 offset:64
    s_mov_b64 exec, -1
    s_setprio 0
    s_mov_b32 s79, 524288
SPIN_34:
    ds_read_b32 v1, v244 offset:64
    s_waitcnt lgkmcnt(0)
    v_readfirstlane_b32 s78, v1
    s_cmp_ge_u32 s78, 4
    s_cbranch_scc1 SPINX_35
    s_sub_u32 s79, s79, 1
    s_cmp_lg_u32 s79, 0
    s_cbranch_scc1 SPIN_34
SPINX_35:
    ds_read_b128 v[96:99], v229 offset:0
    ds_read_b64_tr_b16 v[32:33], v228 offset:8
    ds_read_b64_tr_b16 v[34:35], v228 offset:0
    ds_read_b128 v[100:103], v229 offset:1024
    ds_read_b64_tr_b16 v[36:37], v228 offset:520
    ds_read_b64_tr_b16 v[38:39], v228 offset:512
    ds_read_b128 v[104:107], v229 offset:2048
    ds_read_b64_tr_b16 v[40:41], v228 offset:1032
    ds_read_b64_tr_b16 v[42:43], v228 offset:1024
    ds_read_b128 v[108:111], v229 offset:3072
    ds_read_b64_tr_b16 v[44:45], v228 offset:1544
    ds_read_b64_tr_b16 v[46:47], v228 offset:1536
    ds_read_b128 v[112:115], v229 offset:4096
    ds_read_b64_tr_b16 v[48:49], v228 offset:2056
    ds_read_b64_tr_b16 v[50:51], v228 offset:2048
    ds_read_b128 v[116:119], v229 offset:5120
    ds_read_b64_tr_b16 v[52:53], v228 offset:2568
    ds_read_b64_tr_b16 v[54:55], v228 offset:2560
    ds_read_b128 v[120:123], v229 offset:6144
    ds_read_b64_tr_b16 v[56:57], v228 offset:3080
    ds_read_b64_tr_b16 v[58:59], v228 offset:3072
    ds_read_b128 v[124:127], v229 offset:7168
    ds_read_b64_tr_b16 v[60:61], v228 offset:3592
    ds_read_b64_tr_b16 v[62:63], v228 offset:3584
    s_waitcnt lgkmcnt(15)
    v_mfma_f32_16x16x32_bf16 v[192:195], v[32:35], v[96:99], 0
    v_mfma_f32_16x16x32_bf16 v[196:199], v[32:35], v[100:103], 0
    v_mfma_f32_16x16x32_bf16 v[196:199], v[36:39], v[96:99], v[196:199]
    ds_read_b128 v[128:131], v230 offset:0
    v_mfma_f32_16x16x32_bf16 v[200:203], v[36:39], v[100:103], 0
    ds_read_b64_tr_b16 v[64:65], v228 offset:72
    v_mfma_f32_16x16x32_bf16 v[200:203], v[32:35], v[104:107], v[200:203]
    ds_read_b64_tr_b16 v[66:67], v228 offset:64
    v_mfma_f32_16x16x32_bf16 v[204:207], v[36:39], v[104:107], 0
    ds_read_b128 v[132:135], v230 offset:1024
    v_mfma_f32_16x16x32_bf16 v[200:203], v[40:43], v[96:99], v[200:203]
    ds_read_b64_tr_b16 v[68:69], v228 offset:584
    v_mfma_f32_16x16x32_bf16 v[204:207], v[40:43], v[100:103], v[204:207]
    ds_read_b64_tr_b16 v[70:71], v228 offset:576
    v_mfma_f32_16x16x32_bf16 v[208:211], v[40:43], v[104:107], 0
    ds_read_b128 v[136:139], v230 offset:2048
    s_waitcnt lgkmcnt(15)
    v_mfma_f32_16x16x32_bf16 v[204:207], v[32:35], v[108:111], v[204:207]
    ds_read_b64_tr_b16 v[72:73], v228 offset:1096
    v_mfma_f32_16x16x32_bf16 v[208:211], v[36:39], v[108:111], v[208:211]
    ds_read_b64_tr_b16 v[74:75], v228 offset:1088
    v_mfma_f32_16x16x32_bf16 v[212:215], v[40:43], v[108:111], 0
    ds_read_b128 v[140:143], v230 offset:3072
    v_mfma_f32_16x16x32_bf16 v[204:207], v[44:47], v[96:99], v[204:207]
    ds_read_b64_tr_b16 v[76:77], v228 offset:1608
    v_mfma_f32_16x16x32_bf16 v[208:211], v[44:47], v[100:103], v[208:211]
    ds_read_b64_tr_b16 v[78:79], v228 offset:1600
    v_mfma_f32_16x16x32_bf16 v[212:215], v[44:47], v[104:107], v[212:215]
    ds_read_b128 v[144:147], v230 offset:4096
    v_mfma_f32_16x16x32_bf16 v[216:219], v[44:47], v[108:111], 0
    ds_read_b64_tr_b16 v[80:81], v228 offset:2120
    v_mfma_f32_16x16x32_bf16 v[208:211], v[32:35], v[112:115], v[208:211]
    ds_read_b64_tr_b16 v[82:83], v228 offset:2112
    v_mfma_f32_16x16x32_bf16 v[212:215], v[36:39], v[112:115], v[212:215]
    ds_read_b128 v[148:151], v230 offset:5120
    v_mfma_f32_16x16x32_bf16 v[216:219], v[40:43], v[112:115], v[216:219]
    ds_read_b64_tr_b16 v[84:85], v228 offset:2632
    v_mfma_f32_16x16x32_bf16 v[220:223], v[44:47], v[112:115], 0
    ds_read_b64_tr_b16 v[86:87], v228 offset:2624
    v_mfma_f32_16x16x32_bf16 v[208:211], v[48:51], v[96:99], v[208:211]
    ds_read_b128 v[152:155], v230 offset:6144
    v_mfma_f32_16x16x32_bf16 v[212:215], v[48:51], v[100:103], v[212:215]
    ds_read_b64_tr_b16 v[88:89], v228 offset:3144
    v_mfma_f32_16x16x32_bf16 v[216:219], v[48:51], v[104:107], v[216:219]
    ds_read_b64_tr_b16 v[90:91], v228 offset:3136
    v_mfma_f32_16x16x32_bf16 v[220:223], v[48:51], v[108:111], v[220:223]
    ds_read_b128 v[156:159], v230 offset:7168
    v_mfma_f32_16x16x32_bf16 v[212:215], v[32:35], v[116:119], v[212:215]
    ds_read_b64_tr_b16 v[92:93], v228 offset:3656
    v_mfma_f32_16x16x32_bf16 v[216:219], v[36:39], v[116:119], v[216:219]
    ds_read_b64_tr_b16 v[94:95], v228 offset:3648
    v_mfma_f32_16x16x32_bf16 v[220:223], v[40:43], v[116:119], v[220:223]
    v_subrev_u32 v232, 4, v232
    s_waitcnt lgkmcnt(15)
    v_mfma_f32_16x16x32_bf16 v[212:215], v[52:55], v[96:99], v[212:215]
    v_and_b32 v8, 32, v232
    v_mfma_f32_16x16x32_bf16 v[216:219], v[52:55], v[100:103], v[216:219]
    v_add_u32 v8, v8, v232
    v_mfma_f32_16x16x32_bf16 v[220:223], v[52:55], v[104:107], v[220:223]
    v_lshl_add_u32 v231, v8, 4, s28
    v_mfma_f32_16x16x32_bf16 v[216:219], v[32:35], v[120:123], v[216:219]
    v_subrev_u32 v232, 4, v232
    v_mfma_f32_16x16x32_bf16 v[220:223], v[36:39], v[120:123], v[220:223]
    v_and_b32 v8, 32, v232
    v_mfma_f32_16x16x32_bf16 v[216:219], v[56:59], v[96:99], v[216:219]
    v_add_u32 v8, v8, v232
    v_mfma_f32_16x16x32_bf16 v[220:223], v[56:59], v[100:103], v[220:223]
    v_lshl_add_u32 v232, v8, 4, s28
    v_mfma_f32_16x16x32_bf16 v[220:223], v[32:35], v[124:127], v[220:223]
    s_lshl_b32 s72, s74, 2
    s_add_u32 s72, s72, 163168
    v_mfma_f32_16x16x32_bf16 v[220:223], v[60:63], v[96:99], v[220:223]
    v_mov_b32 v238, s72
    v_mfma_f32_16x16x32_bf16 v[192:195], v[64:67], v[128:131], v[192:195]
    v_xor_b32 v7, 4, v238
    v_mfma_f32_16x16x32_bf16 v[196:199], v[64:67], v[132:135], v[196:199]
    v_lshrrev_b32 v1, 4, v0
    v_mfma_f32_16x16x32_bf16 v[196:199], v[68:71], v[128:131], v[196:199]
    ds_read_b128 v[96:99], v231 offset:0
    v_mfma_f32_16x16x32_bf16 v[200:203], v[68:71], v[132:135], v[200:203]
    ds_read_b64_tr_b16 v[32:33], v228 offset:136
    v_mfma_f32_16x16x32_bf16 v[200:203], v[64:67], v[136:139], v[200:203]
    ds_read_b64_tr_b16 v[34:35], v228 offset:128
    s_waitcnt vmcnt(0)
    s_mov_b64 exec, 1
    ds_add_u32 v237, v245 offset:0
    s_mov_b64 exec, -1
    v_mfma_f32_16x16x32_bf16 v[204:207], v[68:71], v[136:139], v[204:207]
    ds_read_b128 v[100:103], v231 offset:1024
    v_mfma_f32_16x16x32_bf16 v[200:203], v[72:75], v[128:131], v[200:203]
    ds_read_b64_tr_b16 v[36:37], v228 offset:648
    v_mfma_f32_16x16x32_bf16 v[204:207], v[72:75], v[132:135], v[204:207]
    ds_read_b64_tr_b16 v[38:39], v228 offset:640
    v_mfma_f32_16x16x32_bf16 v[208:211], v[72:75], v[136:139], v[208:211]
    ds_read_b128 v[104:107], v231 offset:2048
    s_waitcnt lgkmcnt(15)
    v_mfma_f32_16x16x32_bf16 v[204:207], v[64:67], v[140:143], v[204:207]
    ds_read_b64_tr_b16 v[40:41], v228 offset:1160
    v_mfma_f32_16x16x32_bf16 v[208:211], v[68:71], v[140:143], v[208:211]
    ds_read_b64_tr_b16 v[42:43], v228 offset:1152
    v_mfma_f32_16x16x32_bf16 v[212:215], v[72:75], v[140:143], v[212:215]
    ds_read_b128 v[108:111], v231 offset:3072
    v_mfma_f32_16x16x32_bf16 v[204:207], v[76:79], v[128:131], v[204:207]
    ds_read_b64_tr_b16 v[44:45], v228 offset:1672
    v_mfma_f32_16x16x32_bf16 v[208:211], v[76:79], v[132:135], v[208:211]
    ds_read_b64_tr_b16 v[46:47], v228 offset:1664
    v_mfma_f32_16x16x32_bf16 v[212:215], v[76:79], v[136:139], v[212:215]
    ds_read_b128 v[112:115], v231 offset:4096
    v_mfma_f32_16x16x32_bf16 v[216:219], v[76:79], v[140:143], v[216:219]
    ds_read_b64_tr_b16 v[48:49], v228 offset:2184
    v_mfma_f32_16x16x32_bf16 v[208:211], v[64:67], v[144:147], v[208:211]
    ds_read_b64_tr_b16 v[50:51], v228 offset:2176
    v_mfma_f32_16x16x32_bf16 v[212:215], v[68:71], v[144:147], v[212:215]
    ds_read_b128 v[116:119], v231 offset:5120
    v_mfma_f32_16x16x32_bf16 v[216:219], v[72:75], v[144:147], v[216:219]
    ds_read_b64_tr_b16 v[52:53], v228 offset:2696
    v_mfma_f32_16x16x32_bf16 v[220:223], v[76:79], v[144:147], v[220:223]
    ds_read_b64_tr_b16 v[54:55], v228 offset:2688
    v_mfma_f32_16x16x32_bf16 v[208:211], v[80:83], v[128:131], v[208:211]
    ds_read_b128 v[120:123], v231 offset:6144
    v_mfma_f32_16x16x32_bf16 v[212:215], v[80:83], v[132:135], v[212:215]
    ds_read_b64_tr_b16 v[56:57], v228 offset:3208
    v_mfma_f32_16x16x32_bf16 v[216:219], v[80:83], v[136:139], v[216:219]
    ds_read_b64_tr_b16 v[58:59], v228 offset:3200
    v_mfma_f32_16x16x32_bf16 v[220:223], v[80:83], v[140:143], v[220:223]
    ds_read_b128 v[124:127], v231 offset:7168
    v_mfma_f32_16x16x32_bf16 v[212:215], v[64:67], v[148:151], v[212:215]
    ds_read_b64_tr_b16 v[60:61], v228 offset:3720
    v_mfma_f32_16x16x32_bf16 v[216:219], v[68:71], v[148:151], v[216:219]
    ds_read_b64_tr_b16 v[62:63], v228 offset:3712
    v_mfma_f32_16x16x32_bf16 v[220:223], v[72:75], v[148:151], v[220:223]
    v_and_b32 v2, 15, v0
    s_waitcnt lgkmcnt(15)
    v_mfma_f32_16x16x32_bf16 v[212:215], v[84:87], v[128:131], v[212:215]
    v_and_b32 v3, 1, v1
    v_mfma_f32_16x16x32_bf16 v[216:219], v[84:87], v[132:135], v[216:219]
    v_lshlrev_b32 v3, 9, v3
    v_mfma_f32_16x16x32_bf16 v[220:223], v[84:87], v[136:139], v[220:223]
    v_lshl_add_u32 v3, v2, 5, v3
    v_mfma_f32_16x16x32_bf16 v[216:219], v[64:67], v[152:155], v[216:219]
    v_lshrrev_b32 v8, 1, v1
    v_mfma_f32_16x16x32_bf16 v[220:223], v[68:71], v[152:155], v[220:223]
    v_lshl_add_u32 v234, v8, 4, v3
    v_mfma_f32_16x16x32_bf16 v[216:219], v[88:91], v[128:131], v[216:219]
    v_and_b32 v3, 3, v0
    v_mfma_f32_16x16x32_bf16 v[220:223], v[88:91], v[132:135], v[220:223]
    v_xor_b32 v3, v3, v1
    v_mfma_f32_16x16x32_bf16 v[220:223], v[64:67], v[156:159], v[220:223]
    v_lshlrev_b32 v3, 4, v3
    v_mfma_f32_16x16x32_bf16 v[220:223], v[92:95], v[128:131], v[220:223]
    v_lshrrev_b32 v8, 2, v0
    v_mfma_f32_16x16x32_bf16 v[192:195], v[32:35], v[96:99], v[192:195]
    v_lshl_add_u32 v226, v8, 10, v3
    v_mfma_f32_16x16x32_bf16 v[196:199], v[32:35], v[100:103], v[196:199]
    v_lshrrev_b32 v3, 3, v0
    v_mfma_f32_16x16x32_bf16 v[196:199], v[36:39], v[96:99], v[196:199]
    ds_read_b128 v[128:131], v232 offset:0
    v_mfma_f32_16x16x32_bf16 v[200:203], v[36:39], v[100:103], v[200:203]
    ds_read_b64_tr_b16 v[64:65], v228 offset:200
    v_mfma_f32_16x16x32_bf16 v[200:203], v[32:35], v[104:107], v[200:203]
    ds_read_b64_tr_b16 v[66:67], v228 offset:192
    v_mfma_f32_16x16x32_bf16 v[204:207], v[36:39], v[104:107], v[204:207]
    ds_read_b128 v[132:135], v232 offset:1024
    v_mfma_f32_16x16x32_bf16 v[200:203], v[40:43], v[96:99], v[200:203]
    ds_read_b64_tr_b16 v[68:69], v228 offset:712
    v_mfma_f32_16x16x32_bf16 v[204:207], v[40:43], v[100:103], v[204:207]
    ds_read_b64_tr_b16 v[70:71], v228 offset:704
    v_mfma_f32_16x16x32_bf16 v[208:211], v[40:43], v[104:107], v[208:211]
    ds_read_b128 v[136:139], v232 offset:2048
    s_waitcnt lgkmcnt(15)
    v_mfma_f32_16x16x32_bf16 v[204:207], v[32:35], v[108:111], v[204:207]
    ds_read_b64_tr_b16 v[72:73], v228 offset:1224
    v_mfma_f32_16x16x32_bf16 v[208:211], v[36:39], v[108:111], v[208:211]
    ds_read_b64_tr_b16 v[74:75], v228 offset:1216
    v_mfma_f32_16x16x32_bf16 v[212:215], v[40:43], v[108:111], v[212:215]
    ds_read_b128 v[140:143], v232 offset:3072
    v_mfma_f32_16x16x32_bf16 v[204:207], v[44:47], v[96:99], v[204:207]
    ds_read_b64_tr_b16 v[76:77], v228 offset:1736
    v_mfma_f32_16x16x32_bf16 v[208:211], v[44:47], v[100:103], v[208:211]
    ds_read_b64_tr_b16 v[78:79], v228 offset:1728
    v_mfma_f32_16x16x32_bf16 v[212:215], v[44:47], v[104:107], v[212:215]
    ds_read_b128 v[144:147], v232 offset:4096
    v_mfma_f32_16x16x32_bf16 v[216:219], v[44:47], v[108:111], v[216:219]
    ds_read_b64_tr_b16 v[80:81], v228 offset:2248
    v_mfma_f32_16x16x32_bf16 v[208:211], v[32:35], v[112:115], v[208:211]
    ds_read_b64_tr_b16 v[82:83], v228 offset:2240
    v_mfma_f32_16x16x32_bf16 v[212:215], v[36:39], v[112:115], v[212:215]
    ds_read_b128 v[148:151], v232 offset:5120
    v_mfma_f32_16x16x32_bf16 v[216:219], v[40:43], v[112:115], v[216:219]
    ds_read_b64_tr_b16 v[84:85], v228 offset:2760
    v_mfma_f32_16x16x32_bf16 v[220:223], v[44:47], v[112:115], v[220:223]
    ds_read_b64_tr_b16 v[86:87], v228 offset:2752
    v_mfma_f32_16x16x32_bf16 v[208:211], v[48:51], v[96:99], v[208:211]
    ds_read_b128 v[152:155], v232 offset:6144
    v_mfma_f32_16x16x32_bf16 v[212:215], v[48:51], v[100:103], v[212:215]
    ds_read_b64_tr_b16 v[88:89], v228 offset:3272
    v_mfma_f32_16x16x32_bf16 v[216:219], v[48:51], v[104:107], v[216:219]
    ds_read_b64_tr_b16 v[90:91], v228 offset:3264
    v_mfma_f32_16x16x32_bf16 v[220:223], v[48:51], v[108:111], v[220:223]
    ds_read_b128 v[156:159], v232 offset:7168
    v_mfma_f32_16x16x32_bf16 v[212:215], v[32:35], v[116:119], v[212:215]
    ds_read_b64_tr_b16 v[92:93], v228 offset:3784
    v_mfma_f32_16x16x32_bf16 v[216:219], v[36:39], v[116:119], v[216:219]
    ds_read_b64_tr_b16 v[94:95], v228 offset:3776
    v_mfma_f32_16x16x32_bf16 v[220:223], v[40:43], v[116:119], v[220:223]
    v_and_b32 v8, 0x7f, v17
    s_waitcnt lgkmcnt(15)
    v_mfma_f32_16x16x32_bf16 v[212:215], v[52:55], v[96:99], v[212:215]
    v_lshl_add_u32 v235, v3, 12, v8
    v_mfma_f32_16x16x32_bf16 v[216:219], v[52:55], v[100:103], v[216:219]
    s_lshl_b32 s72, s77, 11
    s_add_u32 s72, s72, s21
    s_add_u32 s19, s72, 12288
    s_add_u32 s14, s72, 8192
    v_mfma_f32_16x16x32_bf16 v[220:223], v[52:55], v[104:107], v[220:223]
    s_lshl_b32 s18, s65, 16
    s_lshl_b32 s72, s77, 15
    s_add_u32 s18, s18, s72
    v_mfma_f32_16x16x32_bf16 v[216:219], v[32:35], v[120:123], v[216:219]
    s_lshl_b32 s72, s100, 7
    s_add_u32 s18, s18, s72
    s_lshl_b32 s72, s75, 6
    v_mfma_f32_16x16x32_bf16 v[220:223], v[36:39], v[120:123], v[220:223]
    s_add_u32 s18, s18, s72
    s_add_u32 s20, s18, 15360
    s_mov_b32 s38, 0x200000
    v_mfma_f32_16x16x32_bf16 v[216:219], v[56:59], v[96:99], v[216:219]
    s_lshl_b32 s12, s100, 18
    s_lshl_b32 s13, s74, 16
    s_add_u32 s12, s12, s13
    v_mfma_f32_16x16x32_bf16 v[220:223], v[56:59], v[100:103], v[220:223]
    s_lshl_b32 s13, s65, 7
    s_add_u32 s12, s12, s13
    s_add_u32 s12, s12, 2359296
    s_add_u32 s13, s12, 31744
    v_mfma_f32_16x16x32_bf16 v[220:223], v[32:35], v[124:127], v[220:223]
    s_lshr_b32 s32, s2, 3
    s_lshl_b32 s32, s32, 1
    s_add_u32 s32, s32, s77
    v_mfma_f32_16x16x32_bf16 v[220:223], v[60:63], v[96:99], v[220:223]
    s_lshl_b32 s32, s32, 4
    s_add_u32 s32, s32, s75
    s_lshl_b32 s32, s32, 3
    v_mfma_f32_16x16x32_bf16 v[192:195], v[64:67], v[128:131], v[192:195]
    s_and_b32 s24, s2, 7
    s_add_u32 s32, s32, s24
    s_lshl_b32 s32, s32, 2
    v_mfma_f32_16x16x32_bf16 v[196:199], v[64:67], v[132:135], v[196:199]
    s_add_u32 s32, s32, 10747904
    s_lshl_b32 s33, s100, 2
    s_add_u32 s33, s33, s74
    v_mfma_f32_16x16x32_bf16 v[196:199], v[68:71], v[128:131], v[196:199]
    s_lshl_b32 s33, s33, 1
    s_lshr_b32 s24, s65, 4
    s_add_u32 s33, s33, s24
    v_mfma_f32_16x16x32_bf16 v[200:203], v[68:71], v[132:135], v[200:203]
    s_lshl_b32 s33, s33, 2
    s_and_b32 s24, s65, 3
    s_add_u32 s33, s33, s24
    v_mfma_f32_16x16x32_bf16 v[200:203], v[64:67], v[136:139], v[200:203]
    s_lshl_b32 s33, s33, 7
    s_add_u32 s33, s33, 10747904
    v_mfma_f32_16x16x32_bf16 v[204:207], v[68:71], v[136:139], v[204:207]
    v_mfma_f32_16x16x32_bf16 v[200:203], v[72:75], v[128:131], v[200:203]
    v_mfma_f32_16x16x32_bf16 v[204:207], v[72:75], v[132:135], v[204:207]
    v_mfma_f32_16x16x32_bf16 v[208:211], v[72:75], v[136:139], v[208:211]
    s_waitcnt lgkmcnt(14)
    v_mfma_f32_16x16x32_bf16 v[204:207], v[64:67], v[140:143], v[204:207]
    v_mfma_f32_16x16x32_bf16 v[208:211], v[68:71], v[140:143], v[208:211]
    v_mfma_f32_16x16x32_bf16 v[212:215], v[72:75], v[140:143], v[212:215]
    s_waitcnt lgkmcnt(12)
    v_mfma_f32_16x16x32_bf16 v[204:207], v[76:79], v[128:131], v[204:207]
    v_mfma_f32_16x16x32_bf16 v[208:211], v[76:79], v[132:135], v[208:211]
    v_mfma_f32_16x16x32_bf16 v[212:215], v[76:79], v[136:139], v[212:215]
    v_mfma_f32_16x16x32_bf16 v[216:219], v[76:79], v[140:143], v[216:219]
    s_waitcnt lgkmcnt(11)
    v_mfma_f32_16x16x32_bf16 v[208:211], v[64:67], v[144:147], v[208:211]
    v_mfma_f32_16x16x32_bf16 v[212:215], v[68:71], v[144:147], v[212:215]
    v_mfma_f32_16x16x32_bf16 v[216:219], v[72:75], v[144:147], v[216:219]
    v_mfma_f32_16x16x32_bf16 v[220:223], v[76:79], v[144:147], v[220:223]
    s_waitcnt lgkmcnt(9)
    v_mfma_f32_16x16x32_bf16 v[208:211], v[80:83], v[128:131], v[208:211]
    v_mfma_f32_16x16x32_bf16 v[212:215], v[80:83], v[132:135], v[212:215]
    v_mfma_f32_16x16x32_bf16 v[216:219], v[80:83], v[136:139], v[216:219]
    v_mfma_f32_16x16x32_bf16 v[220:223], v[80:83], v[140:143], v[220:223]
    s_waitcnt lgkmcnt(8)
    v_mfma_f32_16x16x32_bf16 v[212:215], v[64:67], v[148:151], v[212:215]
    v_mfma_f32_16x16x32_bf16 v[216:219], v[68:71], v[148:151], v[216:219]
    v_mfma_f32_16x16x32_bf16 v[220:223], v[72:75], v[148:151], v[220:223]
    s_waitcnt lgkmcnt(6)
    v_mfma_f32_16x16x32_bf16 v[212:215], v[84:87], v[128:131], v[212:215]
    v_mfma_f32_16x16x32_bf16 v[216:219], v[84:87], v[132:135], v[216:219]
    s_mov_b64 exec, 1
    ds_write_b32 v238, v245 offset:80
    s_mov_b64 exec, -1
    v_mfma_f32_16x16x32_bf16 v[220:223], v[84:87], v[136:139], v[220:223]
    s_waitcnt lgkmcnt(6)
    v_mfma_f32_16x16x32_bf16 v[216:219], v[64:67], v[152:155], v[216:219]
    v_mfma_f32_16x16x32_bf16 v[220:223], v[68:71], v[152:155], v[220:223]
    s_waitcnt lgkmcnt(4)
    v_mfma_f32_16x16x32_bf16 v[216:219], v[88:91], v[128:131], v[216:219]
    v_mfma_f32_16x16x32_bf16 v[220:223], v[88:91], v[132:135], v[220:223]
    s_waitcnt lgkmcnt(3)
    v_mfma_f32_16x16x32_bf16 v[220:223], v[64:67], v[156:159], v[220:223]
    s_waitcnt lgkmcnt(1)
    v_mfma_f32_16x16x32_bf16 v[220:223], v[92:95], v[128:131], v[220:223]
    s_setprio 3
    s_mov_b32 s79, 524288
SPIN_36:
    ds_read_b32 v6, v7 offset:80
    s_waitcnt lgkmcnt(0)
    v_readfirstlane_b32 s78, v6
    s_cmp_ge_u32 s78, 1
    s_cbranch_scc1 SPINX_37
    s_sub_u32 s79, s79, 1
    s_cmp_lg_u32 s79, 0
    s_cbranch_scc1 SPIN_36
SPINX_37:
    s_mov_b32 m0, s19
    s_nop 0
    buffer_load_dwordx4 v226, s[36:39], s18 offen lds
    buffer_load_dwordx4 v226, s[36:39], s20 offen offset:1024 lds
    s_cmp_eq_u32 s77, 0
    s_cbranch_scc0 XB_38
    ds_write_b128 v233, v[208:211] offset:0
    ds_write_b128 v233, v[212:215] offset:1024
    ds_write_b128 v233, v[216:219] offset:2048
    ds_write_b128 v233, v[220:223] offset:3072
    s_mov_b64 exec, 1
    ds_write_b32 v238, v245 offset:96
    s_mov_b64 exec, -1
    s_mov_b32 s79, 524288
SPIN_40:
    ds_read_b32 v6, v7 offset:96
    s_waitcnt lgkmcnt(0)
    v_readfirstlane_b32 s78, v6
    s_cmp_ge_u32 s78, 1
    s_cbranch_scc1 SPINX_41
    s_sub_u32 s79, s79, 1
    s_cmp_lg_u32 s79, 0
    s_cbranch_scc1 SPIN_40
SPINX_41:
    ds_read_b128 v[32:35], v233 offset:4096
    ds_read_b128 v[36:39], v233 offset:5120
    ds_read_b128 v[40:43], v233 offset:6144
    ds_read_b128 v[44:47], v233 offset:7168
    s_waitcnt lgkmcnt(3)
    v_add_f32 v32, v32, v192
    v_add_f32 v33, v33, v193
    v_add_f32 v34, v34, v194
    v_add_f32 v35, v35, v195
    v_cvt_pk_bf16_f32 v48, v32, v33
    v_cvt_pk_bf16_f32 v49, v34, v35
    s_waitcnt lgkmcnt(2)
    v_add_f32 v36, v36, v196
    v_add_f32 v37, v37, v197
    v_add_f32 v38, v38, v198
    v_add_f32 v39, v39, v199
    v_cvt_pk_bf16_f32 v50, v36, v37
    v_cvt_pk_bf16_f32 v51, v38, v39
    s_nop 0
    v_permlane16_swap_b32 v48, v50
    v_permlane16_swap_b32 v49, v51
    buffer_store_dwordx4 v[48:51], v234, s[56:59], s22 offen offset:0 sc1
    s_waitcnt lgkmcnt(1)
    v_add_f32 v40, v40, v200
    v_add_f32 v41, v41, v201
    v_add_f32 v42, v42, v202
    v_add_f32 v43, v43, v203
    v_cvt_pk_bf16_f32 v52, v40, v41
    v_cvt_pk_bf16_f32 v53, v42, v43
    s_waitcnt lgkmcnt(0)
    v_add_f32 v44, v44, v204
    v_add_f32 v45, v45, v205
    v_add_f32 v46, v46, v206
    v_add_f32 v47, v47, v207
    v_cvt_pk_bf16_f32 v54, v44, v45
    v_cvt_pk_bf16_f32 v55, v46, v47
    s_nop 0
    v_permlane16_swap_b32 v52, v54
    v_permlane16_swap_b32 v53, v55
    buffer_store_dwordx4 v[52:55], v234, s[56:59], s22 offen offset:1024 sc1
    s_branch XE_39
XB_38:
    ds_write_b128 v233, v[192:195] offset:4096
    ds_write_b128 v233, v[196:199] offset:5120
    ds_write_b128 v233, v[200:203] offset:6144
    ds_write_b128 v233, v[204:207] offset:7168
    s_mov_b64 exec, 1
    ds_write_b32 v238, v245 offset:96
    s_mov_b64 exec, -1
    s_mov_b32 s79, 524288
SPIN_42:
    ds_read_b32 v6, v7 offset:96
    s_waitcnt lgkmcnt(0)
    v_readfirstlane_b32 s78, v6
    s_cmp_ge_u32 s78, 1
    s_cbranch_scc1 SPINX_43
    s_sub_u32 s79, s79, 1
    s_cmp_lg_u32 s79, 0
    s_cbranch_scc1 SPIN_42
SPINX_43:
    ds_read_b128 v[32:35], v233 offset:0
    ds_read_b128 v[36:39], v233 offset:1024
    ds_read_b128 v[40:43], v233 offset:2048
    ds_read_b128 v[44:47], v233 offset:3072
    s_waitcnt lgkmcnt(3)
    v_add_f32 v32, v32, v208
    v_add_f32 v33, v33, v209
    v_add_f32 v34, v34, v210
    v_add_f32 v35, v35, v211
    v_cvt_pk_bf16_f32 v48, v32, v33
    v_cvt_pk_bf16_f32 v49, v34, v35
    s_waitcnt lgkmcnt(2)
    v_add_f32 v36, v36, v212
    v_add_f32 v37, v37, v213
    v_add_f32 v38, v38, v214
    v_add_f32 v39, v39, v215
    v_cvt_pk_bf16_f32 v50, v36, v37
    v_cvt_pk_bf16_f32 v51, v38, v39
    s_nop 0
    v_permlane16_swap_b32 v48, v50
    v_permlane16_swap_b32 v49, v51
    buffer_store_dwordx4 v[48:51], v234, s[56:59], s22 offen offset:2048 sc1
    s_waitcnt lgkmcnt(1)
    v_add_f32 v40, v40, v216
    v_add_f32 v41, v41, v217
    v_add_f32 v42, v42, v218
    v_add_f32 v43, v43, v219
    v_cvt_pk_bf16_f32 v52, v40, v41
    v_cvt_pk_bf16_f32 v53, v42, v43
    s_waitcnt lgkmcnt(0)
    v_add_f32 v44, v44, v220
    v_add_f32 v45, v45, v221
    v_add_f32 v46, v46, v222
    v_add_f32 v47, v47, v223
    v_cvt_pk_bf16_f32 v54, v44, v45
    v_cvt_pk_bf16_f32 v55, v46, v47
    s_nop 0
    v_permlane16_swap_b32 v52, v54
    v_permlane16_swap_b32 v53, v55
    buffer_store_dwordx4 v[52:55], v234, s[56:59], s22 offen offset:3072 sc1
XE_39:
    v_mov_b32 v1, s60
    v_lshlrev_b32 v2, 7, v0
    s_waitcnt vmcnt(0)
    s_mov_b64 exec, 15
    buffer_store_dword v1, v2, s[56:59], s32 offen sc1
    s_mov_b64 exec, -1
    s_mov_b64 exec, 1
    ds_add_u32 v237, v245 offset:112
    s_mov_b64 exec, -1
    s_mov_b32 s79, 65536
SP_44:
    s_load_dwordx16 s[36:51], s[34:35], s33 glc
SPI_47:
    s_waitcnt lgkmcnt(0)
    s_cmp_eq_u64 s[36:37], s[60:61]
    s_cbranch_scc0 SPR_45
    s_cmp_eq_u64 s[38:39], s[60:61]
    s_cbranch_scc0 SPR_45
    s_cmp_eq_u64 s[40:41], s[60:61]
    s_cbranch_scc0 SPR_45
    s_cmp_eq_u64 s[42:43], s[60:61]
    s_cbranch_scc0 SPR_45
    s_cmp_eq_u64 s[44:45], s[60:61]
    s_cbranch_scc0 SPR_45
    s_cmp_eq_u64 s[46:47], s[60:61]
    s_cbranch_scc0 SPR_45
    s_cmp_eq_u64 s[48:49], s[60:61]
    s_cbranch_scc0 SPR_45
    s_cmp_eq_u64 s[50:51], s[60:61]
    s_cbranch_scc1 SPX_46
SPR_45:
    s_sub_u32 s79, s79, 1
    s_cmp_lg_u32 s79, 0
    s_cbranch_scc1 SP_44
SPX_46:
    s_mov_b32 m0, s14
    s_nop 0
    buffer_load_dwordx4 v235, s[56:59], s12 offen offset:0 sc1 lds
    buffer_load_dwordx4 v235, s[56:59], s13 offen offset:1024 sc1 lds
    s_waitcnt vmcnt(0)
    s_waitcnt lgkmcnt(0)
    s_barrier
    s_endpgm
L_END:
    s_endpgm
.section .rodata,"a"
.p2align 6
.amdhsa_kernel parallel_sum__ssm_conv_s4__glu_gated_bilinear__prompt_kernel
  .amdhsa_next_free_vgpr 256
  .amdhsa_next_free_sgpr 102
  .amdhsa_accum_offset 256
  .amdhsa_group_segment_fixed_size 0
  .amdhsa_kernarg_size 128
  .amdhsa_user_sgpr_count 2
  .amdhsa_user_sgpr_kernarg_segment_ptr 1
  .amdhsa_system_sgpr_workgroup_id_x 1
  .amdhsa_float_denorm_mode_32 3
.end_amdhsa_kernel
```
